```python
import torch

def _softmax(x, axis=-1):
    return torch.softmax(x, dim=axis)
def _gelu(x):
    return torch.nn.functional.gelu(x, approximate="tanh")
def _silu(x):
    return torch.nn.functional.silu(x)
def _sigmoid(x):
    return torch.sigmoid(x)
def _layernorm(x, axis=-1, eps=1e-5):
    m = x.mean(dim=axis, keepdim=True)
    v = x.var(dim=axis, keepdim=True, unbiased=False)
    return (x - m) / torch.sqrt(v + eps)
def _scatter_add(tgt, idx, src, axis=0):
    return tgt.clone().index_add_(axis, idx, src)
def _segment_sum(src, seg, n):
    out = torch.zeros((n,) + src.shape[1:], dtype=src.dtype)
    return out.index_add_(0, seg, src)
def _pad(x, pw):
    flat = tuple(v for pair in reversed(pw) for v in pair)
    return torch.nn.functional.pad(x, flat)

kernel_name = 'standalone__mixer_token_mlp__prompt'

def setup_inputs():

    _w = (lambda a: (lambda t: t.to(torch.bfloat16) if t.is_floating_point() else t)(torch.as_tensor(a)))
    B, S, D, F = 1, 2048, 448, 1792
    return {
        "x": _w((lambda *s: torch.randn(*s, dtype=torch.bfloat16) * 0.05)(B, S, D)),
        "w1": _w((lambda *s: torch.randn(*s, dtype=torch.bfloat16) * 0.2)(S, F) * (S ** -0.5)),
        "b1": _w((lambda *s: torch.randn(*s, dtype=torch.bfloat16) * 3.2)(F) * 0.02),
        "w2": _w((lambda *s: torch.randn(*s, dtype=torch.bfloat16) * 0.05)(F, S) * (F ** -0.5)),
        "b2": _w((lambda *s: torch.randn(*s, dtype=torch.bfloat16) * 0.1)(S) * 0.02),
    }

def reference(x, w1, b1, w2, b2):
    B, S, D = x.shape
    h = _layernorm(x, axis=-1)
    u = torch.einsum("bsd,sf->bdf", h, w1) + b1
    u = _gelu(u)
    y = torch.einsum("bdf,fs->bds", u, w2) + b2
    return (lambda x, *d: x.permute(*d))(y, 0, 2, 1)
```

```asm
; @launch grid=(256,1,1) block=(256,1,1) lds=163840
.amdgcn_target "amdgcn-amd-amdhsa--gfx950"
.text
.globl standalone__mixer_token_mlp__prompt_kernel
.p2align 8
.type standalone__mixer_token_mlp__prompt_kernel,@function
standalone__mixer_token_mlp__prompt_kernel:
    s_load_dwordx16 s[4:19], s[0:1], 0
    s_cmp_ge_u32 s2, 256
    s_cbranch_scc1 L_end
    s_getpc_b64 s[56:57]
L_pc:
    v_lshlrev_b32 v3, 6, v0
    v_min_u32 v3, L_end-L_pc, v3
    global_load_dword v7, v3, s[56:57]
    v_add_u32 v3, 0x4000, v3
    v_min_u32 v3, L_end-L_pc, v3
    global_load_dword v8, v3, s[56:57]
    v_and_b32 v1, 63, v0
    v_lshrrev_b32 v4, 6, v0
    v_lshrrev_b32 v6, 5, v0
    v_readfirstlane_b32 s48, v4
    v_mul_u32_u24 v3, 896, v6
    v_and_b32 v4, 31, v0
    v_lshl_add_u32 v3, v4, 5, v3
    v_cmp_gt_u32 vcc, 28, v4
    v_mov_b32 v5, 0x7ffffff0
    s_mul_i32 s56, s2, 7168
    v_cndmask_b32 v3, v5, v3, vcc
    s_mov_b64 s[68:69], vcc
    s_and_b32 s101, s2, 7
    s_lshr_b32 s3, s2, 3
    s_mul_i32 s58, s101, 49
    s_add_u32 s58, s58, 1
    s_lshr_b32 s58, s58, 1
    s_mul_i32 s99, s58, 293
    s_lshr_b32 s99, s99, 11
    s_lshl_b32 s99, s99, 7
    s_add_u32 s58, s58, s3
    s_and_b32 s59, s101, 1
    s_sub_u32 s59, 25, s59
    s_cmp_lt_u32 s3, s59
    s_cselect_b32 s54, 1, 0
    s_mul_i32 s51, s58, 293
    s_lshr_b32 s51, s51, 11
    s_mul_i32 s59, s51, 7
    s_sub_u32 s50, s58, s59
    v_lshrrev_b32 v4, 3, v1
    v_lshrrev_b32 v5, 2, v1
    v_and_b32 v5, 4, v5
    v_and_b32 v6, 7, v1
    v_xor_b32 v5, v5, v6
    v_lshlrev_b32 v5, 4, v5
    v_mul_u32_u24 v120, 3584, v4
    v_add_u32 v120, v120, v5
    v_lshl_add_u32 v124, v4, 12, v5
    v_add_u32 v121, 27648, v120
    v_add_u32 v122, 227328, v120
    v_add_u32 v123, 254976, v120
    s_mul_i32 s61, s48, 28672
    s_mul_i32 s66, s50, 2
    s_mul_i32 s98, s48, 57344
    s_lshl_b32 s59, s51, 7
    s_add_u32 s98, s98, s59
    s_mul_i32 s58, s66, 229376
    s_add_u32 s60, s98, s58
    s_mov_b32 s22, 0x1c0000
    s_mov_b32 s23, 0x20000
    s_mov_b32 s26, 0x700000
    s_mov_b32 s27, 0x20000
    v_mov_b32 v4, 0x1dc600
    s_waitcnt lgkmcnt(0)
    s_mov_b32 s20, s4
    s_and_b32 s21, s5, 0xffff
    buffer_load_dwordx4 v[140:143], v3, s[20:23], s56 offen
    buffer_load_dwordx4 v[144:147], v3, s[20:23], s56 offen offset:16
    global_load_dword v15, v4, s[18:19] sc1
    s_mov_b32 s24, s6
    s_and_b32 s25, s7, 0xffff
    s_cmp_eq_u32 s54, 0
    s_cbranch_scc1 L_idle
    s_add_u32 m0, s61, 0
    s_nop 0
    buffer_load_dwordx4 v120, s[24:27], s60 offen  lds
    buffer_load_dwordx4 v121, s[24:27], s60 offen offset:1024  lds
    buffer_load_dwordx4 v122, s[24:27], s60 offen offset:2048  lds
    buffer_load_dwordx4 v123, s[24:27], s60 offen offset:3072  lds
    s_mov_b32 s40, s8
    s_and_b32 s41, s9, 0xffff
    s_mov_b32 s42, 0xe00
    s_mov_b32 s43, 0x20000
    s_mov_b32 s44, s12
    s_and_b32 s45, s13, 0xffff
    s_mov_b32 s46, 0x1000
    s_mov_b32 s47, 0x20000
    s_mov_b32 s28, s10
    s_and_b32 s29, s11, 0xffff
    s_mov_b32 s30, 0x700000
    s_mov_b32 s31, 0x20000
    s_mov_b32 s32, s18
    s_and_b32 s33, s19, 0xffff
    s_mov_b32 s34, 0x3c0000
    s_mov_b32 s35, 0x20000
    s_mov_b32 s36, s14
    s_and_b32 s37, s15, 0xffff
    s_mov_b32 s38, 0x1c0000
    s_mov_b32 s39, 0x20000
    s_mul_i32 s58, s3, 37
    s_lshr_b32 s58, s58, 8
    s_mul_i32 s59, s58, 7
    s_sub_u32 s52, s3, s59
    s_lshl_b32 s53, s101, 2
    s_lshl_b32 s6, s101, 9
    s_add_u32 s53, s53, s58
    s_cmp_lt_u32 s3, 28
    s_cselect_b32 s55, 1, 0
    s_lshr_b32 s56, s48, 1
    s_lshl_b32 s56, s56, 6
    v_lshrrev_b32 v5, 5, v1
    v_lshlrev_b32 v5, 3, v5
    s_lshl_b32 s57, s51, 2
    s_add_u32 s57, s57, s48
    s_lshl_b32 s57, s57, 5
    buffer_load_dwordx2 v[112:113], v5, s[40:43], s57 offen offset:0
    buffer_load_dwordx2 v[114:115], v5, s[40:43], s57 offen offset:16
    v_and_b32 v6, 31, v1
    v_lshlrev_b32 v6, 1, v6
    s_min_u32 s57, s53, 31
    s_lshl_b32 s57, s57, 7
    s_add_u32 s57, s56, s57
    buffer_load_ushort v8, v6, s[44:47], s57 offen
    v_lshrrev_b32 v3, 5, v0
    v_mul_u32_u24 v3, 1088, v3
    v_and_b32 v4, 31, v0
    v_lshl_add_u32 v3, v4, 5, v3
    v_add_u32 v132, 114688, v3
    v_bfe_u32 v5, v1, 2, 2
    v_mul_u32_u24 v5, 1088, v5
    v_lshrrev_b32 v4, 4, v0
    v_lshl_add_u32 v5, v4, 5, v5
    v_and_b32 v4, 3, v0
    v_lshl_add_u32 v5, v4, 3, v5
    v_add_u32 v133, 114688, v5
    v_lshrrev_b32 v4, 5, v1
    v_lshlrev_b32 v4, 17, v4
    v_and_b32 v6, 31, v1
    v_lshl_add_u32 v134, v6, 4, v4
    s_bfe_u32 s59, s2, 0x20001
    s_lshl_b32 s10, s59, 5
    s_add_u32 s10, s10, s3
    s_lshl_b32 s10, s10, 1
    s_and_b32 s57, s2, 1
    s_add_u32 s10, s10, s57
    s_lshl_b32 s8, s10, 9
    s_lshl_b32 s57, s48, 18
    s_add_u32 s8, s8, s57
    s_add_u32 s9, s8, 0x100000
    s_lshl_b32 s10, s101, 5
    s_add_u32 s10, s10, s3
    s_lshl_b32 s10, s10, 5
    s_add_u32 s10, s10, 0x1c0000
    s_waitcnt vmcnt(8)
    v_lshlrev_b32 v16, 16, v140
    v_and_b32 v17, 0xffff0000, v140
    v_lshlrev_b32 v18, 16, v141
    v_and_b32 v19, 0xffff0000, v141
    v_lshlrev_b32 v20, 16, v142
    v_and_b32 v21, 0xffff0000, v142
    v_lshlrev_b32 v22, 16, v143
    v_and_b32 v23, 0xffff0000, v143
    v_lshlrev_b32 v24, 16, v144
    v_and_b32 v25, 0xffff0000, v144
    v_lshlrev_b32 v26, 16, v145
    v_and_b32 v27, 0xffff0000, v145
    v_lshlrev_b32 v28, 16, v146
    v_and_b32 v29, 0xffff0000, v146
    v_lshlrev_b32 v30, 16, v147
    v_and_b32 v31, 0xffff0000, v147
    v_pk_add_f32 v[32:33], v[16:17], v[18:19]
    v_pk_add_f32 v[34:35], v[20:21], v[22:23]
    v_pk_add_f32 v[36:37], v[24:25], v[26:27]
    v_pk_add_f32 v[38:39], v[28:29], v[30:31]
    v_pk_add_f32 v[32:33], v[32:33], v[34:35]
    v_pk_add_f32 v[36:37], v[36:37], v[38:39]
    v_pk_add_f32 v[32:33], v[32:33], v[36:37]
    v_add_f32 v32, v32, v33
    s_nop 1
    v_add_f32_dpp v32, v32, v32 row_ror:8 row_mask:0xf bank_mask:0xf
    s_nop 1
    v_add_f32_dpp v32, v32, v32 row_ror:4 row_mask:0xf bank_mask:0xf
    s_nop 1
    v_add_f32_dpp v32, v32, v32 row_ror:2 row_mask:0xf bank_mask:0xf
    s_nop 1
    v_add_f32_dpp v32, v32, v32 row_ror:1 row_mask:0xf bank_mask:0xf
    v_mov_b32 v33, v32
    s_nop 1
    v_permlane16_swap_b32 v32, v33
    s_nop 1
    v_add_f32 v32, v32, v33
    v_mul_f32 v40, 0xbb124925, v32
    v_mul_f32 v41, 0xbb124925, v32
    v_pk_add_f32 v[48:49], v[16:17], v[40:41]
    v_pk_add_f32 v[50:51], v[18:19], v[40:41]
    v_pk_add_f32 v[52:53], v[20:21], v[40:41]
    v_pk_add_f32 v[54:55], v[22:23], v[40:41]
    v_pk_add_f32 v[56:57], v[24:25], v[40:41]
    v_pk_add_f32 v[58:59], v[26:27], v[40:41]
    v_pk_add_f32 v[60:61], v[28:29], v[40:41]
    v_pk_add_f32 v[62:63], v[30:31], v[40:41]
    v_pk_mul_f32 v[32:33], v[48:49], v[48:49]
    v_pk_mul_f32 v[34:35], v[50:51], v[50:51]
    v_pk_fma_f32 v[32:33], v[52:53], v[52:53], v[32:33]
    v_pk_fma_f32 v[34:35], v[54:55], v[54:55], v[34:35]
    v_pk_fma_f32 v[32:33], v[56:57], v[56:57], v[32:33]
    v_pk_fma_f32 v[34:35], v[58:59], v[58:59], v[34:35]
    v_pk_fma_f32 v[32:33], v[60:61], v[60:61], v[32:33]
    v_pk_fma_f32 v[34:35], v[62:63], v[62:63], v[34:35]
    v_pk_add_f32 v[32:33], v[32:33], v[34:35]
    v_add_f32 v32, v32, v33
    v_cndmask_b32 v32, 0, v32, s[68:69]
    v_cvt_pk_bf16_f32 v40, v40, v40
    v_and_b32 v40, 0xffff0000, v40
    v_add_f32_dpp v32, v32, v32 row_ror:8 row_mask:0xf bank_mask:0xf
    v_mov_b32 v41, v40
    v_pk_add_f32 v[48:49], v[16:17], v[40:41]
    v_add_f32_dpp v32, v32, v32 row_ror:4 row_mask:0xf bank_mask:0xf
    v_pk_add_f32 v[50:51], v[18:19], v[40:41]
    v_pk_add_f32 v[52:53], v[20:21], v[40:41]
    v_add_f32_dpp v32, v32, v32 row_ror:2 row_mask:0xf bank_mask:0xf
    v_pk_add_f32 v[54:55], v[22:23], v[40:41]
    v_pk_add_f32 v[56:57], v[24:25], v[40:41]
    v_add_f32_dpp v32, v32, v32 row_ror:1 row_mask:0xf bank_mask:0xf
    v_mov_b32 v33, v32
    v_pk_add_f32 v[58:59], v[26:27], v[40:41]
    v_pk_add_f32 v[60:61], v[28:29], v[40:41]
    v_permlane16_swap_b32 v32, v33
    v_pk_add_f32 v[62:63], v[30:31], v[40:41]
    v_cvt_pk_bf16_f32 v140, v48, v49
    v_add_f32 v32, v32, v33
    v_mul_f32 v32, 0x3b124925, v32
    v_cvt_pk_bf16_f32 v32, v32, v32
    v_and_b32 v32, 0xffff0000, v32
    v_add_f32 v32, 0x3727c5ac, v32
    v_cvt_pk_bf16_f32 v32, v32, v32
    v_and_b32 v32, 0xffff0000, v32
    v_sqrt_f32 v32, v32
    v_cvt_pk_bf16_f32 v141, v50, v51
    v_cvt_pk_bf16_f32 v32, v32, v32
    v_and_b32 v32, 0xffff0000, v32
    v_rcp_f32 v32, v32
    v_cvt_pk_bf16_f32 v142, v52, v53
    v_cvt_pk_bf16_f32 v143, v54, v55
    v_cvt_pk_bf16_f32 v144, v56, v57
    v_cvt_pk_bf16_f32 v145, v58, v59
    v_cvt_pk_bf16_f32 v146, v60, v61
    v_cvt_pk_bf16_f32 v147, v62, v63
    v_lshlrev_b32 v48, 16, v140
    v_and_b32 v49, 0xffff0000, v140
    v_lshlrev_b32 v50, 16, v141
    v_and_b32 v51, 0xffff0000, v141
    v_lshlrev_b32 v52, 16, v142
    v_and_b32 v53, 0xffff0000, v142
    v_lshlrev_b32 v54, 16, v143
    v_and_b32 v55, 0xffff0000, v143
    v_lshlrev_b32 v56, 16, v144
    v_and_b32 v57, 0xffff0000, v144
    v_lshlrev_b32 v58, 16, v145
    v_and_b32 v59, 0xffff0000, v145
    v_lshlrev_b32 v60, 16, v146
    v_and_b32 v61, 0xffff0000, v146
    v_lshlrev_b32 v62, 16, v147
    v_and_b32 v63, 0xffff0000, v147
    v_mov_b32 v33, v32
    v_pk_mul_f32 v[48:49], v[48:49], v[32:33]
    v_pk_mul_f32 v[50:51], v[50:51], v[32:33]
    v_pk_mul_f32 v[52:53], v[52:53], v[32:33]
    v_pk_mul_f32 v[54:55], v[54:55], v[32:33]
    v_cvt_pk_bf16_f32 v140, v48, v49
    v_cvt_pk_bf16_f32 v141, v50, v51
    v_cvt_pk_bf16_f32 v142, v52, v53
    v_cvt_pk_bf16_f32 v143, v54, v55
    ds_write_b128 v132, v[140:143] offset:0
    v_pk_mul_f32 v[56:57], v[56:57], v[32:33]
    v_pk_mul_f32 v[58:59], v[58:59], v[32:33]
    v_pk_mul_f32 v[60:61], v[60:61], v[32:33]
    v_pk_mul_f32 v[62:63], v[62:63], v[32:33]
    v_cvt_pk_bf16_f32 v144, v56, v57
    v_cvt_pk_bf16_f32 v145, v58, v59
    v_cvt_pk_bf16_f32 v146, v60, v61
    v_cvt_pk_bf16_f32 v147, v62, v63
    ds_write_b128 v132, v[144:147] offset:16
    s_waitcnt lgkmcnt(0)
    s_barrier
    ds_read_b64_tr_b16 v[148:149], v133
    ds_read_b64_tr_b16 v[150:151], v133 offset:4352
    ds_read_b64_tr_b16 v[152:153], v133 offset:512
    ds_read_b64_tr_b16 v[154:155], v133 offset:4864
    s_cmp_eq_u32 s48, 3
    s_cselect_b32 s9, s8, s9
    s_waitcnt lgkmcnt(2)
    buffer_store_dwordx4 v[148:151], v134, s[32:35], s8 offen sc1
    s_waitcnt lgkmcnt(0)
    s_cbranch_scc1 L_hs2a
    buffer_store_dwordx4 v[152:155], v134, s[32:35], s9 offen sc1
L_hs2a:
    s_add_u32 m0, m0, 0x1000
    s_add_u32 s60, s60, 458752
    s_cmp_ge_u32 s60, 3670016
    s_cselect_b32 s70, 3670016, 0
    s_sub_u32 s60, s60, s70
    buffer_load_dwordx4 v120, s[24:27], s60 offen  lds
    buffer_load_dwordx4 v121, s[24:27], s60 offen offset:1024  lds
    s_mul_i32 s67, s52, 0
    s_lshl_b32 s4, s48, 16
    s_lshl_b32 s56, s53, 7
    s_add_u32 s4, s4, s56
    s_lshl_b32 s56, s67, 18
    s_add_u32 s4, s4, s56
    v_add_u32 v125, 31744, v124
    v_add_u32 v126, 260096, v124
    buffer_load_dwordx4 v122, s[24:27], s60 offen offset:2048  lds
    v_add_u32 v127, 291840, v124
    v_bfe_u32 v3, v1, 2, 2
    v_lshrrev_b32 v4, 5, v1
    v_mul_u32_u24 v4, 4, v4
    v_add_u32 v4, v4, v3
    v_lshlrev_b32 v4, 7, v4
    v_bfe_u32 v3, v1, 3, 1
    s_lshr_b32 s56, s48, 1
    buffer_load_dwordx4 v123, s[24:27], s60 offen offset:3072  lds
    v_xor_b32 v3, s56, v3
    v_lshl_add_u32 v4, v3, 6, v4
    v_bfe_u32 v3, v1, 4, 1
    v_lshl_add_u32 v4, v3, 5, v4
    v_and_b32 v3, 3, v1
    v_lshl_add_u32 v4, v3, 3, v4
    v_add_u32 v12, s61, v4
    v_xor_b32 v13, 64, v12
    s_add_u32 m0, m0, 0x1000
    s_add_u32 s60, s60, 458752
    s_cmp_ge_u32 s60, 3670016
    s_cselect_b32 s70, 3670016, 0
    s_sub_u32 s60, s60, s70
    buffer_load_dwordx4 v120, s[24:27], s60 offen  lds
    s_and_b32 s57, s48, 1
    v_and_b32 v3, 32, v1
    v_lshl_add_u32 v10, v3, 4, v12
    s_lshl_b32 s56, s57, 5
    v_xor_b32 v10, s56, v10
    v_xor_b32 v11, 64, v10
    v_lshlrev_b32 v2, 4, v1
    s_lshl_b32 s56, s57, 8
    buffer_load_dwordx4 v121, s[24:27], s60 offen offset:1024  lds
    v_xor_b32 v116, s56, v2
    s_xor_b32 s56, s48, 1
    s_mul_i32 s56, s56, 6144
    s_add_u32 s56, s56, 114688
    v_add_u32 v128, s56, v2
    s_xor_b32 s56, s48, 2
    s_mul_i32 s56, s56, 6144
    s_add_u32 s56, s56, 114688
    buffer_load_dwordx4 v122, s[24:27], s60 offen offset:2048  lds
    v_add_u32 v129, s56, v2
    s_xor_b32 s56, s48, 3
    s_mul_i32 s56, s56, 6144
    s_add_u32 s56, s56, 114688
    v_add_u32 v130, s56, v2
    s_xor_b32 s56, s48, 0
    s_mul_i32 s56, s56, 6144
    s_add_u32 s56, s56, 114688
    buffer_load_dwordx4 v123, s[24:27], s60 offen offset:3072  lds
    v_add_u32 v131, s56, v2
    v_mov_b32 v104, 0
    v_mov_b32 v105, 0
    v_mov_b32 v106, 0
    v_mov_b32 v107, 0
    v_mov_b32 v108, 0
    v_mov_b32 v109, 0
    v_mov_b32 v110, 0
    s_add_u32 m0, m0, 0x1000
    s_add_u32 s60, s60, 458752
    s_cmp_ge_u32 s60, 3670016
    s_cselect_b32 s70, 3670016, 0
    s_sub_u32 s60, s60, s70
    buffer_load_dwordx4 v120, s[24:27], s60 offen  lds
    v_mov_b32 v111, 0
    v_and_b32 v3, 31, v1
    v_mul_u32_u24 v3, 896, v3
    v_lshrrev_b32 v4, 5, v1
    v_lshl_add_u32 v14, v4, 4, v3
    s_lshl_b32 s14, s53, 1
    s_lshr_b32 s56, s48, 1
    s_add_u32 s14, s14, s56
    buffer_load_dwordx4 v121, s[24:27], s60 offen offset:1024  lds
    s_mul_i32 s14, s14, 28672
    s_lshl_b32 s56, s52, 7
    s_add_u32 s14, s14, s56
    s_lshl_b32 s56, s57, 5
    s_add_u32 s14, s14, s56
    s_lshl_b32 s12, s101, 7
    s_add_u32 s12, s12, 0x1d6000
    s_mov_b32 s64, 0xc0135761
    buffer_load_dwordx4 v122, s[24:27], s60 offen offset:2048  lds
    s_mov_b32 s65, 0xc0135761
    v_mov_b32 v136, 0xbdd2d3e8
    v_mov_b32 v137, 0xbdd2d3e8
    s_lshl_b32 s11, s50, 3
    s_add_u32 s11, s11, s48
    s_mul_i32 s11, s11, 28
    s_add_u32 s11, s11, s51
    s_lshl_b32 s11, s11, 10
    buffer_load_dwordx4 v123, s[24:27], s60 offen offset:3072  lds
    s_add_u32 s11, s11, 0x200000
    s_mov_b32 s17, s11
    s_lshl_b32 s13, s50, 5
    s_add_u32 s13, s13, s51
    s_lshl_b32 s13, s13, 2
    s_add_u32 s13, s13, s48
    s_lshl_b32 s13, s13, 7
    s_add_u32 s13, s13, 0x388000
    s_add_u32 m0, m0, 0x1000
    s_add_u32 s60, s60, 458752
    s_cmp_ge_u32 s60, 3670016
    s_cselect_b32 s70, 3670016, 0
    s_sub_u32 s60, s60, s70
    buffer_load_dwordx4 v120, s[24:27], s60 offen  lds
    v_and_b32 v3, 31, v1
    v_min_u32 v3, 31, v3
    v_and_or_b32 v3, v1, 32, v3
    v_lshlrev_b32 v9, 5, v3
    s_lshl_b32 s100, s48, 11
    s_add_u32 s100, s100, 0x1c0000
    s_lshl_b32 s5, s50, 3
    s_add_u32 s5, s5, s48
    s_mul_i32 s5, s5, 32768
    s_waitcnt vmcnt(13)
    v_readfirstlane_b32 s49, v15
    v_mov_b32 v6, 0
    s_barrier
    s_mul_i32 s49, s49, 0x9E3779B1
    s_add_u32 s49, s49, 0x6A09E667
    v_mov_b32 v15, s49
    s_cmp_eq_u32 s48, 0
    s_cbranch_scc0 L_hfa
    s_mov_b64 exec, 1
    buffer_store_dword v15, v6, s[32:35], s10 offen sc1
    s_mov_b64 exec, -1
L_hfa:
    v_lshlrev_b32 v96, 16, v112
    v_and_b32 v97, 0xffff0000, v112
    v_lshlrev_b32 v98, 16, v113
    v_and_b32 v99, 0xffff0000, v113
    buffer_load_dwordx4 v121, s[24:27], s60 offen offset:1024  lds
    v_lshlrev_b32 v100, 16, v114
    v_and_b32 v101, 0xffff0000, v114
    v_lshlrev_b32 v102, 16, v115
    v_and_b32 v103, 0xffff0000, v115
    buffer_load_dwordx4 v122, s[24:27], s60 offen offset:2048  lds
    buffer_load_dwordx4 v123, s[24:27], s60 offen offset:3072  lds
    s_add_u32 m0, m0, 0x1000
    s_add_u32 s60, s60, 458752
    s_cmp_ge_u32 s60, 3670016
    s_cselect_b32 s70, 3670016, 0
    s_sub_u32 s60, s60, s70
    buffer_load_dwordx4 v120, s[24:27], s60 offen  lds
    buffer_load_dwordx4 v121, s[24:27], s60 offen offset:1024  lds
    buffer_load_dwordx4 v122, s[24:27], s60 offen offset:2048  lds
    buffer_load_dwordx4 v123, s[24:27], s60 offen offset:3072  lds
    ds_read_b64_tr_b16 a[0:1], v10 offset:0
    ds_read_b64_tr_b16 a[2:3], v10 offset:512
    ds_read_b64_tr_b16 a[4:5], v11 offset:0
    ds_read_b64_tr_b16 a[6:7], v11 offset:512
    s_add_u32 m0, m0, 0x1000
    s_add_u32 s60, s60, 458752
    s_cmp_ge_u32 s60, 3670016
    s_cselect_b32 s70, 3670016, 0
    s_sub_u32 s60, s60, s70
    buffer_load_dwordx4 v120, s[24:27], s60 offen  lds
    buffer_load_dwordx4 v121, s[24:27], s60 offen offset:1024  lds
    ds_read_b64_tr_b16 a[8:9], v10 offset:2048
    ds_read_b64_tr_b16 a[10:11], v10 offset:2560
    ds_read_b64_tr_b16 a[12:13], v11 offset:2048
    ds_read_b64_tr_b16 a[14:15], v11 offset:2560
    buffer_load_dwordx4 v122, s[24:27], s60 offen offset:2048  lds
    buffer_load_dwordx4 v123, s[24:27], s60 offen offset:3072  lds
    s_waitcnt vmcnt(22)
    ds_read_b64_tr_b16 a[16:17], v10 offset:4096
    ds_read_b64_tr_b16 a[18:19], v10 offset:4608
    ds_read_b64_tr_b16 a[20:21], v11 offset:4096
    ds_read_b64_tr_b16 a[22:23], v11 offset:4608
    s_waitcnt lgkmcnt(8)
    s_mov_b32 m0, s61
    s_add_u32 s60, s60, 458752
    s_cmp_ge_u32 s60, 3670016
    s_cselect_b32 s70, 3670016, 0
    s_sub_u32 s60, s60, s70
    buffer_load_dwordx4 v120, s[24:27], s60 offen  lds
    buffer_load_dwordx4 v121, s[24:27], s60 offen offset:1024  lds
    s_waitcnt vmcnt(22)
    ds_read_b64_tr_b16 a[24:25], v10 offset:6144
    ds_read_b64_tr_b16 a[26:27], v10 offset:6656
    ds_read_b64_tr_b16 a[28:29], v11 offset:6144
    ds_read_b64_tr_b16 a[30:31], v11 offset:6656
    s_waitcnt lgkmcnt(8)
    buffer_load_dwordx4 v122, s[24:27], s60 offen offset:2048  lds
    buffer_load_dwordx4 v123, s[24:27], s60 offen offset:3072  lds
    s_waitcnt vmcnt(22)
    ds_read_b64_tr_b16 a[32:33], v10 offset:8192
    ds_read_b64_tr_b16 a[34:35], v10 offset:8704
    ds_read_b64_tr_b16 a[36:37], v11 offset:8192
    ds_read_b64_tr_b16 a[38:39], v11 offset:8704
    s_waitcnt lgkmcnt(8)
    s_add_u32 m0, m0, 0x1000
    s_add_u32 s60, s98, 3670016
    buffer_load_dwordx4 v120, s[24:27], s60 offen  lds
    buffer_load_dwordx4 v121, s[24:27], s60 offen offset:1024  lds
    s_waitcnt vmcnt(22)
    ds_read_b64_tr_b16 a[40:41], v10 offset:10240
    ds_read_b64_tr_b16 a[42:43], v10 offset:10752
    ds_read_b64_tr_b16 a[44:45], v11 offset:10240
    ds_read_b64_tr_b16 a[46:47], v11 offset:10752
    s_waitcnt lgkmcnt(8)
    buffer_load_dwordx4 v122, s[24:27], s60 offen offset:2048  lds
    buffer_load_dwordx4 v123, s[24:27], s60 offen offset:3072  lds
    s_waitcnt vmcnt(22)
    ds_read_b64_tr_b16 a[48:49], v10 offset:12288
    ds_read_b64_tr_b16 a[50:51], v10 offset:12800
    ds_read_b64_tr_b16 a[52:53], v11 offset:12288
    ds_read_b64_tr_b16 a[54:55], v11 offset:12800
    s_waitcnt lgkmcnt(8)
    s_add_u32 m0, m0, 0x1000
    s_add_u32 s60, s60, 458752
    buffer_load_dwordx4 v120, s[24:27], s60 offen  lds
    buffer_load_dwordx4 v121, s[24:27], s60 offen offset:1024  lds
    s_waitcnt vmcnt(22)
    ds_read_b64_tr_b16 a[56:57], v10 offset:14336
    ds_read_b64_tr_b16 a[58:59], v10 offset:14848
    ds_read_b64_tr_b16 a[60:61], v11 offset:14336
    ds_read_b64_tr_b16 a[62:63], v11 offset:14848
    s_waitcnt lgkmcnt(8)
    buffer_load_dwordx4 v122, s[24:27], s60 offen offset:2048  lds
    buffer_load_dwordx4 v123, s[24:27], s60 offen offset:3072  lds
    s_waitcnt vmcnt(22)
    ds_read_b64_tr_b16 a[64:65], v10 offset:16384
    ds_read_b64_tr_b16 a[66:67], v10 offset:16896
    ds_read_b64_tr_b16 a[68:69], v11 offset:16384
    ds_read_b64_tr_b16 a[70:71], v11 offset:16896
    s_waitcnt lgkmcnt(8)
    s_add_u32 m0, m0, 0x1000
    s_add_u32 s60, s60, 458752
    buffer_load_dwordx4 v120, s[24:27], s60 offen  lds
    buffer_load_dwordx4 v121, s[24:27], s60 offen offset:1024  lds
    s_waitcnt vmcnt(22)
    ds_read_b64_tr_b16 a[72:73], v10 offset:18432
    ds_read_b64_tr_b16 a[74:75], v10 offset:18944
    ds_read_b64_tr_b16 a[76:77], v11 offset:18432
    ds_read_b64_tr_b16 a[78:79], v11 offset:18944
    s_waitcnt lgkmcnt(8)
    buffer_load_dwordx4 v122, s[24:27], s60 offen offset:2048  lds
    buffer_load_dwordx4 v123, s[24:27], s60 offen offset:3072  lds
    s_waitcnt vmcnt(22)
    ds_read_b64_tr_b16 a[80:81], v10 offset:20480
    ds_read_b64_tr_b16 a[82:83], v10 offset:20992
    ds_read_b64_tr_b16 a[84:85], v11 offset:20480
    ds_read_b64_tr_b16 a[86:87], v11 offset:20992
    s_waitcnt lgkmcnt(8)
    s_add_u32 m0, m0, 0x1000
    s_add_u32 s60, s60, 458752
    buffer_load_dwordx4 v120, s[24:27], s60 offen  lds
    buffer_load_dwordx4 v121, s[24:27], s60 offen offset:1024  lds
    s_waitcnt vmcnt(22)
    ds_read_b64_tr_b16 a[88:89], v10 offset:22528
    ds_read_b64_tr_b16 a[90:91], v10 offset:23040
    ds_read_b64_tr_b16 a[92:93], v11 offset:22528
    ds_read_b64_tr_b16 a[94:95], v11 offset:23040
    s_waitcnt lgkmcnt(8)
    buffer_load_dwordx4 v122, s[24:27], s60 offen offset:2048  lds
    buffer_load_dwordx4 v123, s[24:27], s60 offen offset:3072  lds
    s_waitcnt vmcnt(22)
    ds_read_b64_tr_b16 a[96:97], v10 offset:24576
    ds_read_b64_tr_b16 a[98:99], v10 offset:25088
    ds_read_b64_tr_b16 a[100:101], v11 offset:24576
    ds_read_b64_tr_b16 a[102:103], v11 offset:25088
    s_waitcnt lgkmcnt(8)
    s_add_u32 m0, m0, 0x1000
    s_add_u32 s60, s60, 458752
    buffer_load_dwordx4 v120, s[24:27], s60 offen  lds
    buffer_load_dwordx4 v121, s[24:27], s60 offen offset:1024  lds
    s_waitcnt vmcnt(22)
    ds_read_b64_tr_b16 a[104:105], v10 offset:26624
    ds_read_b64_tr_b16 a[106:107], v10 offset:27136
    ds_read_b64_tr_b16 a[108:109], v11 offset:26624
    ds_read_b64_tr_b16 a[110:111], v11 offset:27136
    s_waitcnt lgkmcnt(8)
    buffer_load_dwordx4 v122, s[24:27], s60 offen offset:2048  lds
    buffer_load_dwordx4 v123, s[24:27], s60 offen offset:3072  lds
    s_waitcnt vmcnt(22)
    ds_read_b64_tr_b16 a[112:113], v10 offset:0
    ds_read_b64_tr_b16 a[114:115], v10 offset:512
    ds_read_b64_tr_b16 a[116:117], v11 offset:0
    ds_read_b64_tr_b16 a[118:119], v11 offset:512
    s_waitcnt lgkmcnt(8)
    s_add_u32 m0, m0, 0x1000
    s_add_u32 s60, s60, 458752
    buffer_load_dwordx4 v120, s[24:27], s60 offen  lds
    buffer_load_dwordx4 v121, s[24:27], s60 offen offset:1024  lds
    s_waitcnt vmcnt(22)
    ds_read_b64_tr_b16 a[120:121], v10 offset:2048
    ds_read_b64_tr_b16 a[122:123], v10 offset:2560
    ds_read_b64_tr_b16 a[124:125], v11 offset:2048
    ds_read_b64_tr_b16 a[126:127], v11 offset:2560
    s_waitcnt lgkmcnt(8)
    buffer_load_dwordx4 v122, s[24:27], s60 offen offset:2048  lds
    buffer_load_dwordx4 v123, s[24:27], s60 offen offset:3072  lds
    buffer_load_dword v7, v9, s[32:35], s100 offen sc1
    s_waitcnt vmcnt(23)
    ds_read_b64_tr_b16 a[128:129], v10 offset:4096
    ds_read_b64_tr_b16 a[130:131], v10 offset:4608
    ds_read_b64_tr_b16 a[132:133], v11 offset:4096
    ds_read_b64_tr_b16 a[134:135], v11 offset:4608
    s_waitcnt lgkmcnt(8)
    s_mov_b32 m0, s61
    s_add_u32 s60, s60, 458752
    buffer_load_dwordx4 v120, s[24:27], s60 offen  lds
    buffer_load_dwordx4 v121, s[24:27], s60 offen offset:1024  lds
    s_waitcnt vmcnt(23)
    ds_read_b64_tr_b16 a[136:137], v10 offset:6144
    ds_read_b64_tr_b16 a[138:139], v10 offset:6656
    ds_read_b64_tr_b16 a[140:141], v11 offset:6144
    ds_read_b64_tr_b16 a[142:143], v11 offset:6656
    s_waitcnt lgkmcnt(8)
    buffer_load_dwordx4 v122, s[24:27], s60 offen offset:2048  lds
    buffer_load_dwordx4 v123, s[24:27], s60 offen offset:3072  lds
    s_waitcnt vmcnt(23)
    ds_read_b64_tr_b16 a[144:145], v10 offset:8192
    ds_read_b64_tr_b16 a[146:147], v10 offset:8704
    ds_read_b64_tr_b16 a[148:149], v11 offset:8192
    ds_read_b64_tr_b16 a[150:151], v11 offset:8704
    s_waitcnt lgkmcnt(8)
    s_add_u32 m0, m0, 0x1000
    s_add_u32 s60, s60, 458752
    buffer_load_dwordx4 v120, s[24:27], s60 offen  lds
    buffer_load_dwordx4 v121, s[24:27], s60 offen offset:1024  lds
    s_waitcnt vmcnt(23)
    ds_read_b64_tr_b16 a[152:153], v10 offset:10240
    ds_read_b64_tr_b16 a[154:155], v10 offset:10752
    ds_read_b64_tr_b16 a[156:157], v11 offset:10240
    ds_read_b64_tr_b16 a[158:159], v11 offset:10752
    s_waitcnt lgkmcnt(8)
    buffer_load_dwordx4 v122, s[24:27], s60 offen offset:2048  lds
    buffer_load_dwordx4 v123, s[24:27], s60 offen offset:3072  lds
    s_waitcnt vmcnt(23)
    ds_read_b64_tr_b16 a[160:161], v10 offset:12288
    ds_read_b64_tr_b16 a[162:163], v10 offset:12800
    ds_read_b64_tr_b16 a[164:165], v11 offset:12288
    ds_read_b64_tr_b16 a[166:167], v11 offset:12800
    s_waitcnt vmcnt(21)
    ds_read_b64_tr_b16 a[168:169], v10 offset:14336
    ds_read_b64_tr_b16 a[170:171], v10 offset:14848
    ds_read_b64_tr_b16 a[172:173], v11 offset:14336
    ds_read_b64_tr_b16 a[174:175], v11 offset:14848
    s_waitcnt vmcnt(19)
    ds_read_b64_tr_b16 a[176:177], v10 offset:16384
    ds_read_b64_tr_b16 a[178:179], v10 offset:16896
    ds_read_b64_tr_b16 a[180:181], v11 offset:16384
    ds_read_b64_tr_b16 a[182:183], v11 offset:16896
    s_waitcnt vmcnt(17)
    ds_read_b64_tr_b16 a[184:185], v10 offset:18432
    ds_read_b64_tr_b16 a[186:187], v10 offset:18944
    ds_read_b64_tr_b16 a[188:189], v11 offset:18432
    ds_read_b64_tr_b16 a[190:191], v11 offset:18944
    s_waitcnt vmcnt(15)
    ds_read_b64_tr_b16 a[192:193], v10 offset:20480
    ds_read_b64_tr_b16 a[194:195], v10 offset:20992
    ds_read_b64_tr_b16 a[196:197], v11 offset:20480
    ds_read_b64_tr_b16 a[198:199], v11 offset:20992
    s_waitcnt vmcnt(13)
    ds_read_b64_tr_b16 a[200:201], v10 offset:22528
    ds_read_b64_tr_b16 a[202:203], v10 offset:23040
    ds_read_b64_tr_b16 a[204:205], v11 offset:22528
    ds_read_b64_tr_b16 a[206:207], v11 offset:23040
    s_waitcnt vmcnt(11)
    ds_read_b64_tr_b16 a[208:209], v10 offset:24576
    ds_read_b64_tr_b16 a[210:211], v10 offset:25088
    ds_read_b64_tr_b16 a[212:213], v11 offset:24576
    ds_read_b64_tr_b16 a[214:215], v11 offset:25088
    s_waitcnt vmcnt(9)
    ds_read_b64_tr_b16 a[216:217], v10 offset:26624
    ds_read_b64_tr_b16 a[218:219], v10 offset:27136
    ds_read_b64_tr_b16 a[220:221], v11 offset:26624
    ds_read_b64_tr_b16 a[222:223], v11 offset:27136
    s_waitcnt vmcnt(8)
    v_cmp_ne_u32 vcc, s49, v7
    s_mov_b32 s63, 0
    s_cmp_eq_u64 vcc, 0
    s_cbranch_scc1 L_polld_2
L_poll_1:
    s_mov_b64 exec, vcc
    s_sleep 6
    buffer_load_dword v7, v9, s[32:35], s100 offen sc1
    s_add_u32 s63, s63, 1
    s_waitcnt vmcnt(0)
    v_cmp_ne_u32 vcc, s49, v7
    s_cmp_ge_u32 s63, 0x40000
    s_cbranch_scc1 L_polld_2
    s_cmp_eq_u64 vcc, 0
    s_cbranch_scc0 L_poll_1
L_polld_2:
    s_mov_b64 exec, -1
    s_add_u32 s71, s5, 16384
    s_lshl_b32 s59, s66, 10
    s_add_u32 s62, s5, s59
    buffer_load_dwordx4 v[140:143], v2, s[32:35], s62 offen sc1
    buffer_load_dwordx4 v[144:147], v2, s[32:35], s62 offen offset:1024 sc1
    s_add_u32 s62, s62, 2048
    s_cmp_ge_u32 s62, s71
    s_cselect_b32 s59, 16384, 0
    s_sub_u32 s62, s62, s59
    buffer_load_dwordx4 v[148:151], v2, s[32:35], s62 offen sc1
    buffer_load_dwordx4 v[152:155], v2, s[32:35], s62 offen offset:1024 sc1
    s_add_u32 s62, s62, 2048
    s_cmp_ge_u32 s62, s71
    s_cselect_b32 s59, 16384, 0
    s_sub_u32 s62, s62, s59
    buffer_load_dwordx4 v[156:159], v2, s[32:35], s62 offen sc1
    buffer_load_dwordx4 v[160:163], v2, s[32:35], s62 offen offset:1024 sc1
    s_add_u32 s62, s62, 2048
    s_cmp_ge_u32 s62, s71
    s_cselect_b32 s59, 16384, 0
    s_sub_u32 s62, s62, s59
    buffer_load_dwordx4 v[164:167], v2, s[32:35], s62 offen sc1
    buffer_load_dwordx4 v[168:171], v2, s[32:35], s62 offen offset:1024 sc1
    s_add_u32 s62, s62, 2048
    s_cmp_ge_u32 s62, s71
    s_cselect_b32 s59, 16384, 0
    s_sub_u32 s62, s62, s59
    buffer_load_dwordx4 v[172:175], v2, s[32:35], s62 offen sc1
    buffer_load_dwordx4 v[176:179], v2, s[32:35], s62 offen offset:1024 sc1
    s_add_u32 s62, s62, 2048
    s_cmp_ge_u32 s62, s71
    s_cselect_b32 s59, 16384, 0
    s_sub_u32 s62, s62, s59
    buffer_load_dwordx4 v[180:183], v2, s[32:35], s62 offen sc1
    s_waitcnt vmcnt(10)
    v_mfma_f32_32x32x16_bf16 v[32:47], a[4:7], v[140:143], 0
    buffer_load_dwordx4 v[184:187], v2, s[32:35], s62 offen offset:1024 sc1
    v_mfma_f32_32x32x16_bf16 v[16:31], a[0:3], v[140:143], 0
    ds_read_b64_tr_b16 a[224:225], v10 offset:0
    ds_read_b64_tr_b16 a[226:227], v10 offset:512
    ds_read_b64_tr_b16 a[228:229], v11 offset:0
    ds_read_b64_tr_b16 a[230:231], v11 offset:512
    ds_read_b64_tr_b16 a[232:233], v10 offset:2048
    ds_read_b64_tr_b16 a[234:235], v10 offset:2560
    ds_read_b64_tr_b16 a[236:237], v11 offset:2048
    ds_read_b64_tr_b16 a[238:239], v11 offset:2560
    s_waitcnt vmcnt(10)
    v_mfma_f32_32x32x16_bf16 v[32:47], a[12:15], v[144:147], v[32:47]
    s_add_u32 s62, s62, 2048
    s_cmp_ge_u32 s62, s71
    s_cselect_b32 s59, 16384, 0
    s_sub_u32 s62, s62, s59
    buffer_load_dwordx4 v[140:143], v2, s[32:35], s62 offen sc1
    v_mfma_f32_32x32x16_bf16 v[16:31], a[8:11], v[144:147], v[16:31]
    ds_read_b64_tr_b16 a[240:241], v10 offset:4096
    ds_read_b64_tr_b16 a[242:243], v10 offset:4608
    ds_read_b64_tr_b16 a[244:245], v11 offset:4096
    ds_read_b64_tr_b16 a[246:247], v11 offset:4608
    ds_read_b64_tr_b16 a[248:249], v10 offset:6144
    ds_read_b64_tr_b16 a[250:251], v10 offset:6656
    ds_read_b64_tr_b16 a[252:253], v11 offset:6144
    ds_read_b64_tr_b16 a[254:255], v11 offset:6656
    s_waitcnt vmcnt(10)
    v_mfma_f32_32x32x16_bf16 v[32:47], a[20:23], v[148:151], v[32:47]
    buffer_load_dwordx4 v[144:147], v2, s[32:35], s62 offen offset:1024 sc1
    v_mfma_f32_32x32x16_bf16 v[16:31], a[16:19], v[148:151], v[16:31]
    s_waitcnt vmcnt(10)
    v_mfma_f32_32x32x16_bf16 v[32:47], a[28:31], v[152:155], v[32:47]
    s_add_u32 s62, s62, 2048
    s_cmp_ge_u32 s62, s71
    s_cselect_b32 s59, 16384, 0
    s_sub_u32 s62, s62, s59
    buffer_load_dwordx4 v[148:151], v2, s[32:35], s62 offen sc1
    v_mfma_f32_32x32x16_bf16 v[16:31], a[24:27], v[152:155], v[16:31]
    s_waitcnt vmcnt(10)
    v_mfma_f32_32x32x16_bf16 v[32:47], a[36:39], v[156:159], v[32:47]
    buffer_load_dwordx4 v[152:155], v2, s[32:35], s62 offen offset:1024 sc1
    v_mfma_f32_32x32x16_bf16 v[16:31], a[32:35], v[156:159], v[16:31]
    s_waitcnt vmcnt(10)
    v_mfma_f32_32x32x16_bf16 v[32:47], a[44:47], v[160:163], v[32:47]
    s_add_u32 s62, s5, 16384
    buffer_load_dwordx4 v[156:159], v2, s[32:35], s62 offen sc1
    v_mfma_f32_32x32x16_bf16 v[16:31], a[40:43], v[160:163], v[16:31]
    s_waitcnt vmcnt(10)
    v_mfma_f32_32x32x16_bf16 v[32:47], a[52:55], v[164:167], v[32:47]
    buffer_load_dwordx4 v[160:163], v2, s[32:35], s62 offen offset:1024 sc1
    v_mfma_f32_32x32x16_bf16 v[16:31], a[48:51], v[164:167], v[16:31]
    s_waitcnt vmcnt(10)
    v_mfma_f32_32x32x16_bf16 v[32:47], a[60:63], v[168:171], v[32:47]
    s_add_u32 s62, s62, 2048
    buffer_load_dwordx4 v[164:167], v2, s[32:35], s62 offen sc1
    v_mfma_f32_32x32x16_bf16 v[16:31], a[56:59], v[168:171], v[16:31]
    s_waitcnt vmcnt(10)
    v_mfma_f32_32x32x16_bf16 v[32:47], a[68:71], v[172:175], v[32:47]
    buffer_load_dwordx4 v[168:171], v2, s[32:35], s62 offen offset:1024 sc1
    v_mfma_f32_32x32x16_bf16 v[16:31], a[64:67], v[172:175], v[16:31]
    s_waitcnt vmcnt(10)
    v_mfma_f32_32x32x16_bf16 v[32:47], a[76:79], v[176:179], v[32:47]
    s_add_u32 s62, s62, 2048
    buffer_load_dwordx4 v[172:175], v2, s[32:35], s62 offen sc1
    v_mfma_f32_32x32x16_bf16 v[16:31], a[72:75], v[176:179], v[16:31]
    s_waitcnt vmcnt(10)
    v_mfma_f32_32x32x16_bf16 v[32:47], a[84:87], v[180:183], v[32:47]
    buffer_load_dwordx4 v[176:179], v2, s[32:35], s62 offen offset:1024 sc1
    v_mfma_f32_32x32x16_bf16 v[16:31], a[80:83], v[180:183], v[16:31]
    s_waitcnt vmcnt(10)
    v_mfma_f32_32x32x16_bf16 v[32:47], a[92:95], v[184:187], v[32:47]
    s_add_u32 s62, s62, 2048
    buffer_load_dwordx4 v[180:183], v2, s[32:35], s62 offen sc1
    v_mfma_f32_32x32x16_bf16 v[16:31], a[88:91], v[184:187], v[16:31]
    s_waitcnt vmcnt(10)
    v_mfma_f32_32x32x16_bf16 v[32:47], a[100:103], v[140:143], v[32:47]
    buffer_load_dwordx4 v[184:187], v2, s[32:35], s62 offen offset:1024 sc1
    v_mfma_f32_32x32x16_bf16 v[16:31], a[96:99], v[140:143], v[16:31]
    s_waitcnt vmcnt(10)
    v_mfma_f32_32x32x16_bf16 v[32:47], a[108:111], v[144:147], v[32:47]
    s_add_u32 s62, s62, 2048
    buffer_load_dwordx4 v[140:143], v2, s[32:35], s62 offen sc1
    v_mfma_f32_32x32x16_bf16 v[16:31], a[104:107], v[144:147], v[16:31]
    s_waitcnt vmcnt(10)
    v_mfma_f32_32x32x16_bf16 v[32:47], a[116:119], v[148:151], v[32:47]
    buffer_load_dwordx4 v[144:147], v2, s[32:35], s62 offen offset:1024 sc1
    v_mfma_f32_32x32x16_bf16 v[16:31], a[112:115], v[148:151], v[16:31]
    s_waitcnt vmcnt(10)
    v_mfma_f32_32x32x16_bf16 v[32:47], a[124:127], v[152:155], v[32:47]
    s_add_u32 s62, s62, 2048
    buffer_load_dwordx4 v[148:151], v2, s[32:35], s62 offen sc1
    v_mfma_f32_32x32x16_bf16 v[16:31], a[120:123], v[152:155], v[16:31]
    s_waitcnt vmcnt(10)
    v_mfma_f32_32x32x16_bf16 v[32:47], a[132:135], v[156:159], v[32:47]
    buffer_load_dwordx4 v[152:155], v2, s[32:35], s62 offen offset:1024 sc1
    v_mfma_f32_32x32x16_bf16 v[16:31], a[128:131], v[156:159], v[16:31]
    s_waitcnt vmcnt(10)
    v_mfma_f32_32x32x16_bf16 v[32:47], a[140:143], v[160:163], v[32:47]
    s_add_u32 s62, s62, 2048
    buffer_load_dwordx4 v[156:159], v2, s[32:35], s62 offen sc1
    v_mfma_f32_32x32x16_bf16 v[16:31], a[136:139], v[160:163], v[16:31]
    s_waitcnt lgkmcnt(15)
    s_waitcnt vmcnt(10)
    v_mfma_f32_32x32x16_bf16 v[32:47], a[148:151], v[164:167], v[32:47]
    buffer_load_dwordx4 v[160:163], v2, s[32:35], s62 offen offset:1024 sc1
    v_mfma_f32_32x32x16_bf16 v[16:31], a[144:147], v[164:167], v[16:31]
    s_waitcnt vmcnt(10)
    v_mfma_f32_32x32x16_bf16 v[32:47], a[156:159], v[168:171], v[32:47]
    s_add_u32 s62, s62, 2048
    buffer_load_dwordx4 v[164:167], v2, s[32:35], s62 offen sc1
    v_mfma_f32_32x32x16_bf16 v[16:31], a[152:155], v[168:171], v[16:31]
    s_waitcnt vmcnt(10)
    v_mfma_f32_32x32x16_bf16 v[32:47], a[164:167], v[172:175], v[32:47]
    buffer_load_dwordx4 v[168:171], v2, s[32:35], s62 offen offset:1024 sc1
    v_mfma_f32_32x32x16_bf16 v[16:31], a[160:163], v[172:175], v[16:31]
    s_waitcnt vmcnt(10)
    v_mfma_f32_32x32x16_bf16 v[32:47], a[172:175], v[176:179], v[32:47]
    s_add_u32 s5, s5, 131072
    s_add_u32 s71, s5, 16384
    s_lshl_b32 s59, s66, 10
    s_add_u32 s62, s5, s59
    buffer_load_dwordx4 v[172:175], v2, s[32:35], s62 offen sc1
    v_mfma_f32_32x32x16_bf16 v[16:31], a[168:171], v[176:179], v[16:31]
    s_waitcnt vmcnt(10)
    v_mfma_f32_32x32x16_bf16 v[32:47], a[180:183], v[180:183], v[32:47]
    buffer_load_dwordx4 v[176:179], v2, s[32:35], s62 offen offset:1024 sc1
    v_mfma_f32_32x32x16_bf16 v[16:31], a[176:179], v[180:183], v[16:31]
    s_waitcnt vmcnt(10)
    v_mfma_f32_32x32x16_bf16 v[32:47], a[188:191], v[184:187], v[32:47]
    s_add_u32 s62, s62, 2048
    s_cmp_ge_u32 s62, s71
    s_cselect_b32 s59, 16384, 0
    s_sub_u32 s62, s62, s59
    buffer_load_dwordx4 v[180:183], v2, s[32:35], s62 offen sc1
    v_mfma_f32_32x32x16_bf16 v[16:31], a[184:187], v[184:187], v[16:31]
    s_waitcnt vmcnt(10)
    v_mfma_f32_32x32x16_bf16 v[32:47], a[196:199], v[140:143], v[32:47]
    buffer_load_dwordx4 v[184:187], v2, s[32:35], s62 offen offset:1024 sc1
    v_mfma_f32_32x32x16_bf16 v[16:31], a[192:195], v[140:143], v[16:31]
    s_waitcnt vmcnt(10)
    v_mfma_f32_32x32x16_bf16 v[32:47], a[204:207], v[144:147], v[32:47]
    s_add_u32 s62, s62, 2048
    s_cmp_ge_u32 s62, s71
    s_cselect_b32 s59, 16384, 0
    s_sub_u32 s62, s62, s59
    buffer_load_dwordx4 v[140:143], v2, s[32:35], s62 offen sc1
    v_mfma_f32_32x32x16_bf16 v[16:31], a[200:203], v[144:147], v[16:31]
    s_waitcnt vmcnt(10)
    v_mfma_f32_32x32x16_bf16 v[32:47], a[212:215], v[148:151], v[32:47]
    buffer_load_dwordx4 v[144:147], v2, s[32:35], s62 offen offset:1024 sc1
    v_mfma_f32_32x32x16_bf16 v[16:31], a[208:211], v[148:151], v[16:31]
    s_waitcnt vmcnt(10)
    v_mfma_f32_32x32x16_bf16 v[32:47], a[220:223], v[152:155], v[32:47]
    s_add_u32 s62, s62, 2048
    s_cmp_ge_u32 s62, s71
    s_cselect_b32 s59, 16384, 0
    s_sub_u32 s62, s62, s59
    buffer_load_dwordx4 v[148:151], v2, s[32:35], s62 offen sc1
    v_mfma_f32_32x32x16_bf16 v[16:31], a[216:219], v[152:155], v[16:31]
    s_waitcnt lgkmcnt(12)
    s_waitcnt vmcnt(10)
    v_mfma_f32_32x32x16_bf16 v[32:47], a[228:231], v[156:159], v[32:47]
    buffer_load_dwordx4 v[152:155], v2, s[32:35], s62 offen offset:1024 sc1
    v_mfma_f32_32x32x16_bf16 v[16:31], a[224:227], v[156:159], v[16:31]
    s_waitcnt lgkmcnt(8)
    s_waitcnt vmcnt(10)
    v_mfma_f32_32x32x16_bf16 v[32:47], a[236:239], v[160:163], v[32:47]
    s_add_u32 s62, s62, 2048
    s_cmp_ge_u32 s62, s71
    s_cselect_b32 s59, 16384, 0
    s_sub_u32 s62, s62, s59
    buffer_load_dwordx4 v[156:159], v2, s[32:35], s62 offen sc1
    v_mfma_f32_32x32x16_bf16 v[16:31], a[232:235], v[160:163], v[16:31]
    s_waitcnt lgkmcnt(4)
    s_waitcnt vmcnt(10)
    v_mfma_f32_32x32x16_bf16 v[32:47], a[244:247], v[164:167], v[32:47]
    buffer_load_dwordx4 v[160:163], v2, s[32:35], s62 offen offset:1024 sc1
    v_mfma_f32_32x32x16_bf16 v[16:31], a[240:243], v[164:167], v[16:31]
    s_waitcnt lgkmcnt(0)
    s_waitcnt vmcnt(10)
    v_mfma_f32_32x32x16_bf16 v[32:47], a[252:255], v[168:171], v[32:47]
    s_add_u32 s62, s62, 2048
    s_cmp_ge_u32 s62, s71
    s_cselect_b32 s59, 16384, 0
    s_sub_u32 s62, s62, s59
    buffer_load_dwordx4 v[164:167], v2, s[32:35], s62 offen sc1
    v_mfma_f32_32x32x16_bf16 v[16:31], a[248:251], v[168:171], v[16:31]
    s_waitcnt vmcnt(10)
    v_mfma_f32_32x32x16_bf16 v[64:79], a[4:7], v[172:175], 0
    buffer_load_dwordx4 v[168:171], v2, s[32:35], s62 offen offset:1024 sc1
    v_mfma_f32_32x32x16_bf16 v[48:63], a[0:3], v[172:175], 0
    s_waitcnt vmcnt(10)
    v_mfma_f32_32x32x16_bf16 v[64:79], a[12:15], v[176:179], v[64:79]
    s_add_u32 s62, s62, 2048
    s_cmp_ge_u32 s62, s71
    s_cselect_b32 s59, 16384, 0
    s_sub_u32 s62, s62, s59
    buffer_load_dwordx4 v[172:175], v2, s[32:35], s62 offen sc1
    v_mfma_f32_32x32x16_bf16 v[48:63], a[8:11], v[176:179], v[48:63]
    s_waitcnt vmcnt(10)
    v_mfma_f32_32x32x16_bf16 v[64:79], a[20:23], v[180:183], v[64:79]
    buffer_load_dwordx4 v[176:179], v2, s[32:35], s62 offen offset:1024 sc1
    v_mfma_f32_32x32x16_bf16 v[48:63], a[16:19], v[180:183], v[48:63]
    s_waitcnt vmcnt(10)
    v_mfma_f32_32x32x16_bf16 v[64:79], a[28:31], v[184:187], v[64:79]
    s_add_u32 s62, s62, 2048
    s_cmp_ge_u32 s62, s71
    s_cselect_b32 s59, 16384, 0
    s_sub_u32 s62, s62, s59
    buffer_load_dwordx4 v[180:183], v2, s[32:35], s62 offen sc1
    ds_write_b128 v129, v[32:35] offset:2048
    v_mfma_f32_32x32x16_bf16 v[48:63], a[24:27], v[184:187], v[48:63]
    ds_write_b128 v129, v[36:39] offset:3072
    ds_write_b128 v130, v[40:43] offset:4096
    s_waitcnt vmcnt(10)
    v_mfma_f32_32x32x16_bf16 v[64:79], a[36:39], v[140:143], v[64:79]
    buffer_load_dwordx4 v[184:187], v2, s[32:35], s62 offen offset:1024 sc1
    ds_write_b128 v130, v[44:47] offset:5120
    v_mfma_f32_32x32x16_bf16 v[48:63], a[32:35], v[140:143], v[48:63]
    ds_write_b128 v128, v[24:27] offset:0
    ds_write_b128 v128, v[28:31] offset:1024
    s_waitcnt vmcnt(10)
    v_mfma_f32_32x32x16_bf16 v[64:79], a[44:47], v[144:147], v[64:79]
    s_add_u32 s62, s5, 16384
    buffer_load_dwordx4 v[140:143], v2, s[32:35], s62 offen sc1
    v_mfma_f32_32x32x16_bf16 v[48:63], a[40:43], v[144:147], v[48:63]
    s_waitcnt vmcnt(10)
    v_mfma_f32_32x32x16_bf16 v[64:79], a[52:55], v[148:151], v[64:79]
    buffer_load_dwordx4 v[144:147], v2, s[32:35], s62 offen offset:1024 sc1
    v_mfma_f32_32x32x16_bf16 v[48:63], a[48:51], v[148:151], v[48:63]
    s_waitcnt vmcnt(10)
    v_mfma_f32_32x32x16_bf16 v[64:79], a[60:63], v[152:155], v[64:79]
    s_add_u32 s62, s62, 2048
    buffer_load_dwordx4 v[148:151], v2, s[32:35], s62 offen sc1
    s_waitcnt lgkmcnt(0)
    s_barrier
    ds_read_b128 v[24:27], v131 offset:0
    v_mfma_f32_32x32x16_bf16 v[48:63], a[56:59], v[152:155], v[48:63]
    ds_read_b128 v[32:35], v131 offset:2048
    ds_read_b128 v[40:43], v131 offset:4096
    ds_read_b128 v[28:31], v131 offset:1024
    s_waitcnt vmcnt(10)
    v_mfma_f32_32x32x16_bf16 v[64:79], a[68:71], v[156:159], v[64:79]
    buffer_load_dwordx4 v[152:155], v2, s[32:35], s62 offen offset:1024 sc1
    ds_read_b128 v[36:39], v131 offset:3072
    ds_read_b128 v[44:47], v131 offset:5120
    v_mfma_f32_32x32x16_bf16 v[48:63], a[64:67], v[156:159], v[48:63]
    s_waitcnt vmcnt(10)
    v_mfma_f32_32x32x16_bf16 v[64:79], a[76:79], v[160:163], v[64:79]
    s_add_u32 s62, s62, 2048
    buffer_load_dwordx4 v[156:159], v2, s[32:35], s62 offen sc1
    v_mfma_f32_32x32x16_bf16 v[48:63], a[72:75], v[160:163], v[48:63]
    s_waitcnt vmcnt(10)
    v_mfma_f32_32x32x16_bf16 v[64:79], a[84:87], v[164:167], v[64:79]
    buffer_load_dwordx4 v[160:163], v2, s[32:35], s62 offen offset:1024 sc1
    s_waitcnt lgkmcnt(3)
    v_pk_add_f32 v[32:33], v[32:33], v[40:41]
    v_pk_add_f32 v[16:17], v[16:17], v[24:25]
    v_mfma_f32_32x32x16_bf16 v[48:63], a[80:83], v[164:167], v[48:63]
    v_pk_add_f32 v[34:35], v[34:35], v[42:43]
    v_pk_add_f32 v[18:19], v[18:19], v[26:27]
    v_pk_add_f32 v[16:17], v[16:17], v[32:33]
    v_pk_add_f32 v[18:19], v[18:19], v[34:35]
    s_waitcnt lgkmcnt(0)
    v_pk_add_f32 v[36:37], v[36:37], v[44:45]
    s_waitcnt vmcnt(10)
    v_mfma_f32_32x32x16_bf16 v[64:79], a[92:95], v[168:171], v[64:79]
    s_add_u32 s62, s62, 2048
    buffer_load_dwordx4 v[164:167], v2, s[32:35], s62 offen sc1
    v_pk_add_f32 v[20:21], v[20:21], v[28:29]
    v_pk_add_f32 v[38:39], v[38:39], v[46:47]
    v_pk_add_f32 v[22:23], v[22:23], v[30:31]
    v_mfma_f32_32x32x16_bf16 v[48:63], a[88:91], v[168:171], v[48:63]
    v_pk_add_f32 v[20:21], v[20:21], v[36:37]
    v_pk_add_f32 v[22:23], v[22:23], v[38:39]
    v_cvt_pk_bf16_f32 v88, v16, v17
    v_cvt_pk_bf16_f32 v89, v18, v19
    v_cvt_pk_bf16_f32 v90, v20, v21
    v_cvt_pk_bf16_f32 v91, v22, v23
    s_waitcnt vmcnt(10)
    v_mfma_f32_32x32x16_bf16 v[64:79], a[100:103], v[172:175], v[64:79]
    buffer_load_dwordx4 v[168:171], v2, s[32:35], s62 offen offset:1024 sc1
    v_lshlrev_b32 v16, 16, v88
    v_and_b32 v17, 0xffff0000, v88
    v_lshlrev_b32 v18, 16, v89
    v_mfma_f32_32x32x16_bf16 v[48:63], a[96:99], v[172:175], v[48:63]
    v_and_b32 v19, 0xffff0000, v89
    v_lshlrev_b32 v20, 16, v90
    v_and_b32 v21, 0xffff0000, v90
    v_lshlrev_b32 v22, 16, v91
    v_and_b32 v23, 0xffff0000, v91
    v_pk_add_f32 v[16:17], v[16:17], v[96:97]
    s_waitcnt vmcnt(10)
    v_mfma_f32_32x32x16_bf16 v[64:79], a[108:111], v[176:179], v[64:79]
    s_add_u32 s62, s62, 2048
    buffer_load_dwordx4 v[172:175], v2, s[32:35], s62 offen sc1
    v_pk_add_f32 v[18:19], v[18:19], v[98:99]
    v_pk_add_f32 v[20:21], v[20:21], v[100:101]
    v_pk_add_f32 v[22:23], v[22:23], v[102:103]
    v_mfma_f32_32x32x16_bf16 v[48:63], a[104:107], v[176:179], v[48:63]
    v_cvt_pk_bf16_f32 v88, v16, v17
    v_cvt_pk_bf16_f32 v89, v18, v19
    v_cvt_pk_bf16_f32 v90, v20, v21
    v_cvt_pk_bf16_f32 v91, v22, v23
    v_lshlrev_b32 v16, 16, v88
    v_and_b32 v17, 0xffff0000, v88
    s_waitcnt vmcnt(10)
    v_mfma_f32_32x32x16_bf16 v[64:79], a[116:119], v[180:183], v[64:79]
    buffer_load_dwordx4 v[176:179], v2, s[32:35], s62 offen offset:1024 sc1
    v_lshlrev_b32 v18, 16, v89
    v_and_b32 v19, 0xffff0000, v89
    v_lshlrev_b32 v20, 16, v90
    v_mfma_f32_32x32x16_bf16 v[48:63], a[112:115], v[180:183], v[48:63]
    v_and_b32 v21, 0xffff0000, v90
    v_lshlrev_b32 v22, 16, v91
    v_and_b32 v23, 0xffff0000, v91
    v_pk_mul_f32 v[80:81], v[16:17], v[16:17]
    v_pk_mul_f32 v[82:83], v[18:19], v[18:19]
    v_pk_mul_f32 v[84:85], v[20:21], v[20:21]
    s_waitcnt vmcnt(10)
    v_mfma_f32_32x32x16_bf16 v[64:79], a[124:127], v[184:187], v[64:79]
    s_add_u32 s62, s62, 2048
    buffer_load_dwordx4 v[180:183], v2, s[32:35], s62 offen sc1
    v_pk_mul_f32 v[86:87], v[22:23], v[22:23]
    v_pk_fma_f32 v[80:81], v[80:81], v[136:137], s[64:65]
    v_pk_fma_f32 v[82:83], v[82:83], v[136:137], s[64:65]
    v_mfma_f32_32x32x16_bf16 v[48:63], a[120:123], v[184:187], v[48:63]
    v_pk_fma_f32 v[84:85], v[84:85], v[136:137], s[64:65]
    v_pk_fma_f32 v[86:87], v[86:87], v[136:137], s[64:65]
    v_pk_mul_f32 v[80:81], v[80:81], v[16:17]
    v_pk_mul_f32 v[82:83], v[82:83], v[18:19]
    v_pk_mul_f32 v[84:85], v[84:85], v[20:21]
    v_pk_mul_f32 v[86:87], v[86:87], v[22:23]
    s_waitcnt vmcnt(10)
    v_mfma_f32_32x32x16_bf16 v[64:79], a[132:135], v[140:143], v[64:79]
    buffer_load_dwordx4 v[184:187], v2, s[32:35], s62 offen offset:1024 sc1
    v_exp_f32 v80, v80
    v_exp_f32 v81, v81
    v_mfma_f32_32x32x16_bf16 v[48:63], a[128:131], v[140:143], v[48:63]
    v_exp_f32 v82, v82
    v_exp_f32 v83, v83
    v_exp_f32 v84, v84
    s_waitcnt vmcnt(10)
    v_mfma_f32_32x32x16_bf16 v[64:79], a[140:143], v[144:147], v[64:79]
    s_add_u32 s62, s62, 2048
    buffer_load_dwordx4 v[140:143], v2, s[32:35], s62 offen sc1
    v_exp_f32 v85, v85
    v_exp_f32 v86, v86
    v_mfma_f32_32x32x16_bf16 v[48:63], a[136:139], v[144:147], v[48:63]
    v_exp_f32 v87, v87
    v_pk_add_f32 v[80:81], v[80:81], 1.0 op_sel_hi:[1,0]
    v_pk_add_f32 v[82:83], v[82:83], 1.0 op_sel_hi:[1,0]
    v_pk_add_f32 v[84:85], v[84:85], 1.0 op_sel_hi:[1,0]
    v_pk_add_f32 v[86:87], v[86:87], 1.0 op_sel_hi:[1,0]
    s_waitcnt vmcnt(10)
    v_mfma_f32_32x32x16_bf16 v[64:79], a[148:151], v[148:151], v[64:79]
    buffer_load_dwordx4 v[144:147], v2, s[32:35], s62 offen offset:1024 sc1
    v_rcp_f32 v80, v80
    v_rcp_f32 v81, v81
    v_mfma_f32_32x32x16_bf16 v[48:63], a[144:147], v[148:151], v[48:63]
    v_rcp_f32 v82, v82
    v_rcp_f32 v83, v83
    v_rcp_f32 v84, v84
    s_waitcnt vmcnt(10)
    v_mfma_f32_32x32x16_bf16 v[64:79], a[156:159], v[152:155], v[64:79]
    s_add_u32 s62, s62, 2048
    buffer_load_dwordx4 v[148:151], v2, s[32:35], s62 offen sc1
    v_rcp_f32 v85, v85
    v_rcp_f32 v86, v86
    v_mfma_f32_32x32x16_bf16 v[48:63], a[152:155], v[152:155], v[48:63]
    v_rcp_f32 v87, v87
    v_pk_mul_f32 v[80:81], v[80:81], v[16:17]
    v_pk_mul_f32 v[82:83], v[82:83], v[18:19]
    v_pk_mul_f32 v[84:85], v[84:85], v[20:21]
    v_pk_mul_f32 v[86:87], v[86:87], v[22:23]
    s_waitcnt vmcnt(10)
    v_mfma_f32_32x32x16_bf16 v[64:79], a[164:167], v[156:159], v[64:79]
    buffer_load_dwordx4 v[152:155], v2, s[32:35], s62 offen offset:1024 sc1
    v_cvt_pk_bf16_f32 v88, v80, v81
    v_cvt_pk_bf16_f32 v89, v82, v83
    v_cvt_pk_bf16_f32 v90, v84, v85
    v_mfma_f32_32x32x16_bf16 v[48:63], a[160:163], v[156:159], v[48:63]
    v_cvt_pk_bf16_f32 v91, v86, v87
    buffer_store_dwordx4 v[88:91], v2, s[32:35], s11 offen sc1
    s_waitcnt vmcnt(11)
    v_mfma_f32_32x32x16_bf16 v[64:79], a[172:175], v[160:163], v[64:79]
    v_mfma_f32_32x32x16_bf16 v[48:63], a[168:171], v[160:163], v[48:63]
    s_add_u32 m0, m0, 0x1000
    s_nop 0
    buffer_load_dwordx4 v124, s[28:31], s4 offen  lds
    s_waitcnt vmcnt(11)
    v_mfma_f32_32x32x16_bf16 v[64:79], a[180:183], v[164:167], v[64:79]
    v_mfma_f32_32x32x16_bf16 v[48:63], a[176:179], v[164:167], v[48:63]
    buffer_load_dwordx4 v125, s[28:31], s4 offen offset:1024  lds
    s_waitcnt vmcnt(11)
    v_mfma_f32_32x32x16_bf16 v[64:79], a[188:191], v[168:171], v[64:79]
    v_mfma_f32_32x32x16_bf16 v[48:63], a[184:187], v[168:171], v[48:63]
    buffer_load_dwordx4 v126, s[28:31], s4 offen offset:2048  lds
    s_waitcnt vmcnt(11)
    v_mfma_f32_32x32x16_bf16 v[64:79], a[196:199], v[172:175], v[64:79]
    v_mfma_f32_32x32x16_bf16 v[48:63], a[192:195], v[172:175], v[48:63]
    buffer_load_dwordx4 v127, s[28:31], s4 offen offset:3072  lds
    s_waitcnt vmcnt(11)
    v_mfma_f32_32x32x16_bf16 v[64:79], a[204:207], v[176:179], v[64:79]
    v_mfma_f32_32x32x16_bf16 v[48:63], a[200:203], v[176:179], v[48:63]
    s_add_u32 m0, m0, 0x1000
    s_add_u32 s4, s4, 524288
    buffer_load_dwordx4 v124, s[28:31], s4 offen  lds
    s_waitcnt vmcnt(11)
    v_mfma_f32_32x32x16_bf16 v[64:79], a[212:215], v[180:183], v[64:79]
    v_mfma_f32_32x32x16_bf16 v[48:63], a[208:211], v[180:183], v[48:63]
    buffer_load_dwordx4 v125, s[28:31], s4 offen offset:1024  lds
    s_waitcnt vmcnt(11)
    v_mfma_f32_32x32x16_bf16 v[64:79], a[220:223], v[184:187], v[64:79]
    v_mfma_f32_32x32x16_bf16 v[48:63], a[216:219], v[184:187], v[48:63]
    buffer_load_dwordx4 v126, s[28:31], s4 offen offset:2048  lds
    s_waitcnt vmcnt(11)
    v_mfma_f32_32x32x16_bf16 v[64:79], a[228:231], v[140:143], v[64:79]
    v_mfma_f32_32x32x16_bf16 v[48:63], a[224:227], v[140:143], v[48:63]
    buffer_load_dwordx4 v127, s[28:31], s4 offen offset:3072  lds
    s_waitcnt vmcnt(11)
    v_mfma_f32_32x32x16_bf16 v[64:79], a[236:239], v[144:147], v[64:79]
    v_mfma_f32_32x32x16_bf16 v[48:63], a[232:235], v[144:147], v[48:63]
    s_add_u32 m0, m0, 0x1000
    s_add_u32 s4, s4, 524288
    buffer_load_dwordx4 v124, s[28:31], s4 offen  lds
    s_waitcnt vmcnt(11)
    v_mfma_f32_32x32x16_bf16 v[64:79], a[244:247], v[148:151], v[64:79]
    v_mfma_f32_32x32x16_bf16 v[48:63], a[240:243], v[148:151], v[48:63]
    buffer_load_dwordx4 v125, s[28:31], s4 offen offset:1024  lds
    s_waitcnt vmcnt(11)
    v_mfma_f32_32x32x16_bf16 v[64:79], a[252:255], v[152:155], v[64:79]
    v_mfma_f32_32x32x16_bf16 v[48:63], a[248:251], v[152:155], v[48:63]
    v_min_u32 v9, 27, v1
    v_lshlrev_b32 v9, 9, v9
    s_lshl_b32 s100, s52, 7
    s_add_u32 s100, s100, s48
    s_lshl_b32 s100, s100, 7
    s_add_u32 s100, s100, 0x388000
    buffer_load_dwordx4 v126, s[28:31], s4 offen offset:2048  lds
    buffer_load_dwordx4 v127, s[28:31], s4 offen offset:3072  lds
    s_add_u32 m0, m0, 0x1000
    s_add_u32 s4, s4, 524288
    buffer_load_dwordx4 v124, s[28:31], s4 offen  lds
    s_nop 4
    buffer_load_dwordx4 v125, s[28:31], s4 offen offset:1024  lds
    s_waitcnt vmcnt(14)
    s_mov_b64 exec, 1
    buffer_store_dword v15, v6, s[32:35], s13 offen sc1
    s_mov_b64 exec, -1
    ds_write_b128 v129, v[64:67] offset:26624
    buffer_load_dwordx4 v126, s[28:31], s4 offen offset:2048  lds
    ds_write_b128 v129, v[68:71] offset:27648
    buffer_load_dwordx4 v127, s[28:31], s4 offen offset:3072  lds
    ds_write_b128 v130, v[72:75] offset:28672
    s_add_u32 m0, m0, 0x1000
    s_add_u32 s4, s4, 524288
    buffer_load_dwordx4 v124, s[28:31], s4 offen  lds
    ds_write_b128 v130, v[76:79] offset:29696
    buffer_load_dwordx4 v125, s[28:31], s4 offen offset:1024  lds
    ds_write_b128 v128, v[56:59] offset:24576
    buffer_load_dwordx4 v126, s[28:31], s4 offen offset:2048  lds
    ds_write_b128 v128, v[60:63] offset:25600
    buffer_load_dwordx4 v127, s[28:31], s4 offen offset:3072  lds
    s_mov_b32 m0, s61
    s_add_u32 s4, s4, 524288
    buffer_load_dwordx4 v124, s[28:31], s4 offen  lds
    buffer_load_dwordx4 v125, s[28:31], s4 offen offset:1024  lds
    buffer_load_dwordx4 v126, s[28:31], s4 offen offset:2048  lds
    s_waitcnt lgkmcnt(0)
    s_barrier
    s_mov_b64 exec, 1
    s_lshl_b32 s58, s3, 2
    s_or_b32 s58, s58, s48
    s_cmp_eq_u32 s58, 32
    s_cbranch_scc0 L_noep
    buffer_store_dword v15, v6, s[32:35], s12 offen sc1
    s_cmp_eq_u32 s2, 64
    s_cbranch_scc0 L_noep
    s_mov_b32 s58, 0x1dc600
    buffer_store_dword v15, v6, s[32:35], s58 offen sc1
L_noep:
    s_mov_b64 exec, -1
    ds_read_b128 v[56:59], v131 offset:24576
    ds_read_b128 v[64:67], v131 offset:26624
    ds_read_b128 v[72:75], v131 offset:28672
    ds_read_b128 v[60:63], v131 offset:25600
    buffer_load_dwordx4 v127, s[28:31], s4 offen offset:3072  lds
    ds_read_b128 v[68:71], v131 offset:27648
    ds_read_b128 v[76:79], v131 offset:29696
    s_waitcnt vmcnt(23)
    ds_read_b64_tr_b16 a[0:1], v12 offset:8192
    ds_read_b64_tr_b16 a[2:3], v12 offset:9216
    ds_read_b64_tr_b16 a[4:5], v13 offset:8192
    ds_read_b64_tr_b16 a[6:7], v13 offset:9216
    s_add_u32 m0, m0, 0x1000
    s_add_u32 s4, s4, 524288
    buffer_load_dwordx4 v124, s[28:31], s4 offen  lds
    buffer_load_dwordx4 v125, s[28:31], s4 offen offset:1024  lds
    s_waitcnt lgkmcnt(7)
    v_pk_add_f32 v[64:65], v[64:65], v[72:73]
    v_pk_add_f32 v[48:49], v[48:49], v[56:57]
    v_pk_add_f32 v[66:67], v[66:67], v[74:75]
    v_pk_add_f32 v[50:51], v[50:51], v[58:59]
    v_pk_add_f32 v[48:49], v[48:49], v[64:65]
    v_pk_add_f32 v[50:51], v[50:51], v[66:67]
    s_waitcnt lgkmcnt(4)
    v_pk_add_f32 v[68:69], v[68:69], v[76:77]
    v_pk_add_f32 v[52:53], v[52:53], v[60:61]
    s_waitcnt vmcnt(23)
    ds_read_b64_tr_b16 a[8:9], v12 offset:10240
    ds_read_b64_tr_b16 a[10:11], v12 offset:11264
    ds_read_b64_tr_b16 a[12:13], v13 offset:10240
    ds_read_b64_tr_b16 a[14:15], v13 offset:11264
    buffer_load_dwordx4 v126, s[28:31], s4 offen offset:2048  lds
    v_pk_add_f32 v[70:71], v[70:71], v[78:79]
    v_pk_add_f32 v[54:55], v[54:55], v[62:63]
    v_pk_add_f32 v[52:53], v[52:53], v[68:69]
    v_pk_add_f32 v[54:55], v[54:55], v[70:71]
    v_cvt_pk_bf16_f32 v92, v48, v49
    v_cvt_pk_bf16_f32 v93, v50, v51
    v_cvt_pk_bf16_f32 v94, v52, v53
    v_cvt_pk_bf16_f32 v95, v54, v55
    v_lshlrev_b32 v48, 16, v92
    v_and_b32 v49, 0xffff0000, v92
    buffer_load_dwordx4 v127, s[28:31], s4 offen offset:3072  lds
    v_lshlrev_b32 v50, 16, v93
    v_and_b32 v51, 0xffff0000, v93
    v_lshlrev_b32 v52, 16, v94
    v_and_b32 v53, 0xffff0000, v94
    v_lshlrev_b32 v54, 16, v95
    v_and_b32 v55, 0xffff0000, v95
    v_pk_add_f32 v[48:49], v[48:49], v[96:97]
    v_pk_add_f32 v[50:51], v[50:51], v[98:99]
    v_pk_add_f32 v[52:53], v[52:53], v[100:101]
    v_pk_add_f32 v[54:55], v[54:55], v[102:103]
    s_waitcnt vmcnt(23)
    ds_read_b64_tr_b16 a[16:17], v12 offset:12288
    ds_read_b64_tr_b16 a[18:19], v12 offset:13312
    ds_read_b64_tr_b16 a[20:21], v13 offset:12288
    ds_read_b64_tr_b16 a[22:23], v13 offset:13312
    s_waitcnt lgkmcnt(8)
    s_add_u32 m0, m0, 0x1000
    s_add_u32 s4, s4, 524288
    buffer_load_dwordx4 v124, s[28:31], s4 offen  lds
    v_cvt_pk_bf16_f32 v92, v48, v49
    v_cvt_pk_bf16_f32 v93, v50, v51
    v_cvt_pk_bf16_f32 v94, v52, v53
    v_cvt_pk_bf16_f32 v95, v54, v55
    v_lshlrev_b32 v48, 16, v92
    v_and_b32 v49, 0xffff0000, v92
    v_lshlrev_b32 v50, 16, v93
    v_and_b32 v51, 0xffff0000, v93
    v_lshlrev_b32 v52, 16, v94
    v_and_b32 v53, 0xffff0000, v94
    buffer_load_dwordx4 v125, s[28:31], s4 offen offset:1024  lds
    v_lshlrev_b32 v54, 16, v95
    v_and_b32 v55, 0xffff0000, v95
    v_pk_mul_f32 v[80:81], v[48:49], v[48:49]
    v_pk_mul_f32 v[82:83], v[50:51], v[50:51]
    v_pk_mul_f32 v[84:85], v[52:53], v[52:53]
    v_pk_mul_f32 v[86:87], v[54:55], v[54:55]
    v_pk_fma_f32 v[80:81], v[80:81], v[136:137], s[64:65]
    v_pk_fma_f32 v[82:83], v[82:83], v[136:137], s[64:65]
    v_pk_fma_f32 v[84:85], v[84:85], v[136:137], s[64:65]
    v_pk_fma_f32 v[86:87], v[86:87], v[136:137], s[64:65]
    s_waitcnt vmcnt(23)
    ds_read_b64_tr_b16 a[24:25], v12 offset:14336
    ds_read_b64_tr_b16 a[26:27], v12 offset:15360
    ds_read_b64_tr_b16 a[28:29], v13 offset:14336
    ds_read_b64_tr_b16 a[30:31], v13 offset:15360
    s_waitcnt lgkmcnt(8)
    buffer_load_dwordx4 v126, s[28:31], s4 offen offset:2048  lds
    v_pk_mul_f32 v[80:81], v[80:81], v[48:49]
    v_pk_mul_f32 v[82:83], v[82:83], v[50:51]
    v_pk_mul_f32 v[84:85], v[84:85], v[52:53]
    v_pk_mul_f32 v[86:87], v[86:87], v[54:55]
    v_exp_f32 v80, v80
    v_exp_f32 v81, v81
    v_exp_f32 v82, v82
    buffer_load_dwordx4 v127, s[28:31], s4 offen offset:3072  lds
    v_exp_f32 v83, v83
    v_exp_f32 v84, v84
    v_exp_f32 v85, v85
    v_exp_f32 v86, v86
    v_exp_f32 v87, v87
    s_waitcnt vmcnt(23)
    ds_read_b64_tr_b16 a[32:33], v12 offset:16384
    ds_read_b64_tr_b16 a[34:35], v12 offset:17408
    ds_read_b64_tr_b16 a[36:37], v13 offset:16384
    ds_read_b64_tr_b16 a[38:39], v13 offset:17408
    s_waitcnt lgkmcnt(8)
    s_add_u32 m0, m0, 0x1000
    s_add_u32 s4, s4, 524288
    buffer_load_dwordx4 v124, s[28:31], s4 offen  lds
    v_pk_add_f32 v[80:81], v[80:81], 1.0 op_sel_hi:[1,0]
    v_pk_add_f32 v[82:83], v[82:83], 1.0 op_sel_hi:[1,0]
    v_pk_add_f32 v[84:85], v[84:85], 1.0 op_sel_hi:[1,0]
    v_pk_add_f32 v[86:87], v[86:87], 1.0 op_sel_hi:[1,0]
    v_rcp_f32 v80, v80
    v_rcp_f32 v81, v81
    v_rcp_f32 v82, v82
    buffer_load_dwordx4 v125, s[28:31], s4 offen offset:1024  lds
    v_rcp_f32 v83, v83
    v_rcp_f32 v84, v84
    v_rcp_f32 v85, v85
    v_rcp_f32 v86, v86
    v_rcp_f32 v87, v87
    s_waitcnt vmcnt(23)
    ds_read_b64_tr_b16 a[40:41], v12 offset:18432
    ds_read_b64_tr_b16 a[42:43], v12 offset:19456
    ds_read_b64_tr_b16 a[44:45], v13 offset:18432
    ds_read_b64_tr_b16 a[46:47], v13 offset:19456
    s_waitcnt lgkmcnt(8)
    buffer_load_dwordx4 v126, s[28:31], s4 offen offset:2048  lds
    v_pk_mul_f32 v[80:81], v[80:81], v[48:49]
    v_pk_mul_f32 v[82:83], v[82:83], v[50:51]
    v_pk_mul_f32 v[84:85], v[84:85], v[52:53]
    v_pk_mul_f32 v[86:87], v[86:87], v[54:55]
    v_cvt_pk_bf16_f32 v92, v80, v81
    v_cvt_pk_bf16_f32 v93, v82, v83
    v_cvt_pk_bf16_f32 v94, v84, v85
    v_cvt_pk_bf16_f32 v95, v86, v87
    s_add_u32 s11, s11, 114688
    buffer_store_dwordx4 v[92:95], v2, s[32:35], s11 offen sc1
    buffer_load_dwordx4 v127, s[28:31], s4 offen offset:3072  lds
    s_waitcnt vmcnt(24)
    ds_read_b64_tr_b16 a[48:49], v12 offset:20480
    ds_read_b64_tr_b16 a[50:51], v12 offset:21504
    ds_read_b64_tr_b16 a[52:53], v13 offset:20480
    ds_read_b64_tr_b16 a[54:55], v13 offset:21504
    s_waitcnt lgkmcnt(8)
    s_add_u32 m0, m0, 0x1000
    s_add_u32 s4, s4, 524288
    buffer_load_dwordx4 v124, s[28:31], s4 offen  lds
    buffer_load_dwordx4 v125, s[28:31], s4 offen offset:1024  lds
    s_waitcnt vmcnt(23)
    ds_read_b64_tr_b16 a[56:57], v12 offset:22528
    ds_read_b64_tr_b16 a[58:59], v12 offset:23552
    ds_read_b64_tr_b16 a[60:61], v13 offset:22528
    ds_read_b64_tr_b16 a[62:63], v13 offset:23552
    s_waitcnt lgkmcnt(8)
    buffer_load_dwordx4 v126, s[28:31], s4 offen offset:2048  lds
    buffer_load_dwordx4 v127, s[28:31], s4 offen offset:3072  lds
    s_waitcnt vmcnt(23)
    ds_read_b64_tr_b16 a[64:65], v12 offset:24576
    ds_read_b64_tr_b16 a[66:67], v12 offset:25600
    ds_read_b64_tr_b16 a[68:69], v13 offset:24576
    ds_read_b64_tr_b16 a[70:71], v13 offset:25600
    s_waitcnt lgkmcnt(8)
    s_add_u32 m0, m0, 0x1000
    s_add_u32 s4, s4, 524288
    buffer_load_dwordx4 v124, s[28:31], s4 offen  lds
    buffer_load_dwordx4 v125, s[28:31], s4 offen offset:1024  lds
    s_waitcnt vmcnt(23)
    ds_read_b64_tr_b16 a[72:73], v12 offset:26624
    ds_read_b64_tr_b16 a[74:75], v12 offset:27648
    ds_read_b64_tr_b16 a[76:77], v13 offset:26624
    ds_read_b64_tr_b16 a[78:79], v13 offset:27648
    s_waitcnt lgkmcnt(8)
    buffer_load_dwordx4 v126, s[28:31], s4 offen offset:2048  lds
    buffer_load_dwordx4 v127, s[28:31], s4 offen offset:3072  lds
    s_waitcnt vmcnt(23)
    ds_read_b64_tr_b16 a[80:81], v12 offset:0
    ds_read_b64_tr_b16 a[82:83], v12 offset:1024
    ds_read_b64_tr_b16 a[84:85], v13 offset:0
    ds_read_b64_tr_b16 a[86:87], v13 offset:1024
    s_waitcnt vmcnt(21)
    ds_read_b64_tr_b16 a[88:89], v12 offset:2048
    ds_read_b64_tr_b16 a[90:91], v12 offset:3072
    ds_read_b64_tr_b16 a[92:93], v13 offset:2048
    ds_read_b64_tr_b16 a[94:95], v13 offset:3072
    s_waitcnt vmcnt(19)
    ds_read_b64_tr_b16 a[96:97], v12 offset:4096
    ds_read_b64_tr_b16 a[98:99], v12 offset:5120
    ds_read_b64_tr_b16 a[100:101], v13 offset:4096
    ds_read_b64_tr_b16 a[102:103], v13 offset:5120
    s_waitcnt vmcnt(9)
    s_add_u32 s13, s13, 114688
    s_mov_b64 exec, 1
    buffer_store_dword v15, v6, s[32:35], s13 offen sc1
    s_mov_b64 exec, -1
    s_branch L_join
L_idle:
    v_lshrrev_b32 v135, 5, v1
    v_mul_u32_u24 v135, 3584, v135
    v_and_b32 v9, 31, v1
    v_lshl_add_u32 v135, v9, 4, v135
    s_lshl_b32 s62, s3, 2
    s_add_u32 s62, s62, s48
    s_sub_u32 s62, s62, -348
    s_mul_i32 s62, s62, 7168
    s_add_u32 s62, s62, s99
    s_cmp_lt_u32 s3, 25
    s_cselect_b32 s70, 0x40000000, 0
    s_cselect_b32 s62, 0, s62
    v_add_u32 v135, s70, v135
    buffer_load_dwordx4 v[224:227], v135, s[24:27], s62 offen
    s_add_u32 s62, s62, 200704
    buffer_load_dwordx4 v[228:231], v135, s[24:27], s62 offen
    s_add_u32 s62, s62, 200704
    buffer_load_dwordx4 v[232:235], v135, s[24:27], s62 offen
    s_add_u32 s62, s62, 200704
    buffer_load_dwordx4 v[236:239], v135, s[24:27], s62 offen
    s_mov_b32 s40, s8
    s_and_b32 s41, s9, 0xffff
    s_mov_b32 s42, 0xe00
    s_mov_b32 s43, 0x20000
    s_mov_b32 s44, s12
    s_and_b32 s45, s13, 0xffff
    s_mov_b32 s46, 0x1000
    s_mov_b32 s47, 0x20000
    s_mov_b32 s28, s10
    s_and_b32 s29, s11, 0xffff
    s_mov_b32 s30, 0x700000
    s_mov_b32 s31, 0x20000
    s_mov_b32 s32, s18
    s_and_b32 s33, s19, 0xffff
    s_mov_b32 s34, 0x3c0000
    s_mov_b32 s35, 0x20000
    s_mov_b32 s36, s14
    s_and_b32 s37, s15, 0xffff
    s_mov_b32 s38, 0x1c0000
    s_mov_b32 s39, 0x20000
    s_mul_i32 s58, s3, 37
    s_lshr_b32 s58, s58, 8
    s_mul_i32 s59, s58, 7
    s_sub_u32 s52, s3, s59
    s_lshl_b32 s53, s101, 2
    s_lshl_b32 s6, s101, 9
    s_add_u32 s53, s53, s58
    s_cmp_lt_u32 s3, 28
    s_cselect_b32 s55, 1, 0
    s_lshr_b32 s56, s48, 1
    s_lshl_b32 s56, s56, 6
    v_and_b32 v6, 31, v1
    v_lshlrev_b32 v6, 1, v6
    s_min_u32 s57, s53, 31
    s_lshl_b32 s57, s57, 7
    s_add_u32 s57, s56, s57
    buffer_load_ushort v8, v6, s[44:47], s57 offen
    v_lshrrev_b32 v3, 5, v0
    v_mul_u32_u24 v3, 1088, v3
    v_and_b32 v4, 31, v0
    v_lshl_add_u32 v3, v4, 5, v3
    v_add_u32 v132, 114688, v3
    v_bfe_u32 v5, v1, 2, 2
    v_mul_u32_u24 v5, 1088, v5
    v_lshrrev_b32 v4, 4, v0
    v_lshl_add_u32 v5, v4, 5, v5
    v_and_b32 v4, 3, v0
    v_lshl_add_u32 v5, v4, 3, v5
    v_add_u32 v133, 114688, v5
    v_lshrrev_b32 v4, 5, v1
    v_lshlrev_b32 v4, 17, v4
    v_and_b32 v6, 31, v1
    v_lshl_add_u32 v134, v6, 4, v4
    s_bfe_u32 s59, s2, 0x20001
    s_lshl_b32 s10, s59, 5
    s_add_u32 s10, s10, s3
    s_lshl_b32 s10, s10, 1
    s_and_b32 s57, s2, 1
    s_add_u32 s10, s10, s57
    s_lshl_b32 s8, s10, 9
    s_lshl_b32 s57, s48, 18
    s_add_u32 s8, s8, s57
    s_add_u32 s9, s8, 0x100000
    s_lshl_b32 s10, s101, 5
    s_add_u32 s10, s10, s3
    s_lshl_b32 s10, s10, 5
    s_add_u32 s10, s10, 0x1c0000
    s_waitcnt vmcnt(6)
    v_lshlrev_b32 v16, 16, v140
    v_and_b32 v17, 0xffff0000, v140
    v_lshlrev_b32 v18, 16, v141
    v_and_b32 v19, 0xffff0000, v141
    v_lshlrev_b32 v20, 16, v142
    v_and_b32 v21, 0xffff0000, v142
    v_lshlrev_b32 v22, 16, v143
    v_and_b32 v23, 0xffff0000, v143
    v_lshlrev_b32 v24, 16, v144
    v_and_b32 v25, 0xffff0000, v144
    v_lshlrev_b32 v26, 16, v145
    v_and_b32 v27, 0xffff0000, v145
    v_lshlrev_b32 v28, 16, v146
    v_and_b32 v29, 0xffff0000, v146
    v_lshlrev_b32 v30, 16, v147
    v_and_b32 v31, 0xffff0000, v147
    v_pk_add_f32 v[32:33], v[16:17], v[18:19]
    v_pk_add_f32 v[34:35], v[20:21], v[22:23]
    v_pk_add_f32 v[36:37], v[24:25], v[26:27]
    v_pk_add_f32 v[38:39], v[28:29], v[30:31]
    v_pk_add_f32 v[32:33], v[32:33], v[34:35]
    v_pk_add_f32 v[36:37], v[36:37], v[38:39]
    v_pk_add_f32 v[32:33], v[32:33], v[36:37]
    v_add_f32 v32, v32, v33
    s_nop 1
    v_add_f32_dpp v32, v32, v32 row_ror:8 row_mask:0xf bank_mask:0xf
    s_nop 1
    v_add_f32_dpp v32, v32, v32 row_ror:4 row_mask:0xf bank_mask:0xf
    s_nop 1
    v_add_f32_dpp v32, v32, v32 row_ror:2 row_mask:0xf bank_mask:0xf
    s_nop 1
    v_add_f32_dpp v32, v32, v32 row_ror:1 row_mask:0xf bank_mask:0xf
    v_mov_b32 v33, v32
    s_nop 1
    v_permlane16_swap_b32 v32, v33
    s_nop 1
    v_add_f32 v32, v32, v33
    v_mul_f32 v40, 0xbb124925, v32
    v_mul_f32 v41, 0xbb124925, v32
    v_pk_add_f32 v[48:49], v[16:17], v[40:41]
    v_pk_add_f32 v[50:51], v[18:19], v[40:41]
    v_pk_add_f32 v[52:53], v[20:21], v[40:41]
    v_pk_add_f32 v[54:55], v[22:23], v[40:41]
    v_pk_add_f32 v[56:57], v[24:25], v[40:41]
    v_pk_add_f32 v[58:59], v[26:27], v[40:41]
    v_pk_add_f32 v[60:61], v[28:29], v[40:41]
    v_pk_add_f32 v[62:63], v[30:31], v[40:41]
    v_pk_mul_f32 v[32:33], v[48:49], v[48:49]
    v_pk_mul_f32 v[34:35], v[50:51], v[50:51]
    v_pk_fma_f32 v[32:33], v[52:53], v[52:53], v[32:33]
    v_pk_fma_f32 v[34:35], v[54:55], v[54:55], v[34:35]
    v_pk_fma_f32 v[32:33], v[56:57], v[56:57], v[32:33]
    v_pk_fma_f32 v[34:35], v[58:59], v[58:59], v[34:35]
    v_pk_fma_f32 v[32:33], v[60:61], v[60:61], v[32:33]
    v_pk_fma_f32 v[34:35], v[62:63], v[62:63], v[34:35]
    v_pk_add_f32 v[32:33], v[32:33], v[34:35]
    v_add_f32 v32, v32, v33
    v_cndmask_b32 v32, 0, v32, s[68:69]
    v_cvt_pk_bf16_f32 v40, v40, v40
    v_and_b32 v40, 0xffff0000, v40
    v_add_f32_dpp v32, v32, v32 row_ror:8 row_mask:0xf bank_mask:0xf
    v_mov_b32 v41, v40
    v_pk_add_f32 v[48:49], v[16:17], v[40:41]
    v_add_f32_dpp v32, v32, v32 row_ror:4 row_mask:0xf bank_mask:0xf
    v_pk_add_f32 v[50:51], v[18:19], v[40:41]
    v_pk_add_f32 v[52:53], v[20:21], v[40:41]
    v_add_f32_dpp v32, v32, v32 row_ror:2 row_mask:0xf bank_mask:0xf
    v_pk_add_f32 v[54:55], v[22:23], v[40:41]
    v_pk_add_f32 v[56:57], v[24:25], v[40:41]
    v_add_f32_dpp v32, v32, v32 row_ror:1 row_mask:0xf bank_mask:0xf
    v_mov_b32 v33, v32
    v_pk_add_f32 v[58:59], v[26:27], v[40:41]
    v_pk_add_f32 v[60:61], v[28:29], v[40:41]
    v_permlane16_swap_b32 v32, v33
    v_pk_add_f32 v[62:63], v[30:31], v[40:41]
    v_cvt_pk_bf16_f32 v140, v48, v49
    v_add_f32 v32, v32, v33
    v_mul_f32 v32, 0x3b124925, v32
    v_cvt_pk_bf16_f32 v32, v32, v32
    v_and_b32 v32, 0xffff0000, v32
    v_add_f32 v32, 0x3727c5ac, v32
    v_cvt_pk_bf16_f32 v32, v32, v32
    v_and_b32 v32, 0xffff0000, v32
    v_sqrt_f32 v32, v32
    v_cvt_pk_bf16_f32 v141, v50, v51
    v_cvt_pk_bf16_f32 v32, v32, v32
    v_and_b32 v32, 0xffff0000, v32
    v_rcp_f32 v32, v32
    v_cvt_pk_bf16_f32 v142, v52, v53
    v_cvt_pk_bf16_f32 v143, v54, v55
    v_cvt_pk_bf16_f32 v144, v56, v57
    v_cvt_pk_bf16_f32 v145, v58, v59
    v_cvt_pk_bf16_f32 v146, v60, v61
    v_cvt_pk_bf16_f32 v147, v62, v63
    v_lshlrev_b32 v48, 16, v140
    v_and_b32 v49, 0xffff0000, v140
    v_lshlrev_b32 v50, 16, v141
    v_and_b32 v51, 0xffff0000, v141
    v_lshlrev_b32 v52, 16, v142
    v_and_b32 v53, 0xffff0000, v142
    v_lshlrev_b32 v54, 16, v143
    v_and_b32 v55, 0xffff0000, v143
    v_lshlrev_b32 v56, 16, v144
    v_and_b32 v57, 0xffff0000, v144
    v_lshlrev_b32 v58, 16, v145
    v_and_b32 v59, 0xffff0000, v145
    v_lshlrev_b32 v60, 16, v146
    v_and_b32 v61, 0xffff0000, v146
    v_lshlrev_b32 v62, 16, v147
    v_and_b32 v63, 0xffff0000, v147
    v_mov_b32 v33, v32
    v_pk_mul_f32 v[48:49], v[48:49], v[32:33]
    v_pk_mul_f32 v[50:51], v[50:51], v[32:33]
    v_pk_mul_f32 v[52:53], v[52:53], v[32:33]
    v_pk_mul_f32 v[54:55], v[54:55], v[32:33]
    v_cvt_pk_bf16_f32 v140, v48, v49
    v_cvt_pk_bf16_f32 v141, v50, v51
    v_cvt_pk_bf16_f32 v142, v52, v53
    v_cvt_pk_bf16_f32 v143, v54, v55
    ds_write_b128 v132, v[140:143] offset:0
    v_pk_mul_f32 v[56:57], v[56:57], v[32:33]
    v_pk_mul_f32 v[58:59], v[58:59], v[32:33]
    v_pk_mul_f32 v[60:61], v[60:61], v[32:33]
    v_pk_mul_f32 v[62:63], v[62:63], v[32:33]
    v_cvt_pk_bf16_f32 v144, v56, v57
    v_cvt_pk_bf16_f32 v145, v58, v59
    v_cvt_pk_bf16_f32 v146, v60, v61
    v_cvt_pk_bf16_f32 v147, v62, v63
    ds_write_b128 v132, v[144:147] offset:16
    s_waitcnt lgkmcnt(0)
    s_barrier
    ds_read_b64_tr_b16 v[148:149], v133
    ds_read_b64_tr_b16 v[150:151], v133 offset:4352
    ds_read_b64_tr_b16 v[152:153], v133 offset:512
    ds_read_b64_tr_b16 v[154:155], v133 offset:4864
    s_cmp_eq_u32 s48, 3
    s_cselect_b32 s9, s8, s9
    s_waitcnt lgkmcnt(2)
    buffer_store_dwordx4 v[148:151], v134, s[32:35], s8 offen sc1
    s_waitcnt lgkmcnt(0)
    s_cbranch_scc1 L_hs2b
    buffer_store_dwordx4 v[152:155], v134, s[32:35], s9 offen sc1
L_hs2b:
    s_add_u32 s62, s62, 200704
    buffer_load_dwordx4 v[240:243], v135, s[24:27], s62 offen
    s_add_u32 s62, s62, 200704
    buffer_load_dwordx4 v[244:247], v135, s[24:27], s62 offen
    s_mul_i32 s67, s52, 0
    s_lshl_b32 s4, s48, 16
    s_lshl_b32 s56, s53, 7
    s_add_u32 s4, s4, s56
    s_lshl_b32 s56, s67, 18
    s_add_u32 s4, s4, s56
    v_add_u32 v125, 31744, v124
    v_add_u32 v126, 260096, v124
    v_add_u32 v127, 291840, v124
    v_bfe_u32 v3, v1, 2, 2
    v_lshrrev_b32 v4, 5, v1
    v_mul_u32_u24 v4, 4, v4
    v_add_u32 v4, v4, v3
    v_lshlrev_b32 v4, 7, v4
    v_bfe_u32 v3, v1, 3, 1
    s_lshr_b32 s56, s48, 1
    v_xor_b32 v3, s56, v3
    v_lshl_add_u32 v4, v3, 6, v4
    v_bfe_u32 v3, v1, 4, 1
    v_lshl_add_u32 v4, v3, 5, v4
    v_and_b32 v3, 3, v1
    v_lshl_add_u32 v4, v3, 3, v4
    v_add_u32 v12, s61, v4
    v_xor_b32 v13, 64, v12
    s_and_b32 s57, s48, 1
    v_lshlrev_b32 v2, 4, v1
    s_lshl_b32 s56, s57, 8
    v_xor_b32 v116, s56, v2
    s_xor_b32 s56, s48, 1
    s_mul_i32 s56, s56, 6144
    s_add_u32 s56, s56, 114688
    v_add_u32 v128, s56, v2
    s_xor_b32 s56, s48, 2
    s_mul_i32 s56, s56, 6144
    s_add_u32 s56, s56, 114688
    v_add_u32 v129, s56, v2
    s_xor_b32 s56, s48, 3
    s_mul_i32 s56, s56, 6144
    s_add_u32 s56, s56, 114688
    v_add_u32 v130, s56, v2
    s_xor_b32 s56, s48, 0
    s_mul_i32 s56, s56, 6144
    s_add_u32 s56, s56, 114688
    v_add_u32 v131, s56, v2
    v_mov_b32 v104, 0
    v_mov_b32 v105, 0
    v_mov_b32 v106, 0
    v_mov_b32 v107, 0
    v_mov_b32 v108, 0
    v_mov_b32 v109, 0
    v_mov_b32 v110, 0
    v_mov_b32 v111, 0
    v_and_b32 v3, 31, v1
    v_mul_u32_u24 v3, 896, v3
    v_lshrrev_b32 v4, 5, v1
    v_lshl_add_u32 v14, v4, 4, v3
    s_lshl_b32 s14, s53, 1
    s_lshr_b32 s56, s48, 1
    s_add_u32 s14, s14, s56
    s_mul_i32 s14, s14, 28672
    s_lshl_b32 s56, s52, 7
    s_add_u32 s14, s14, s56
    s_lshl_b32 s56, s57, 5
    s_add_u32 s14, s14, s56
    s_lshl_b32 s12, s101, 7
    s_add_u32 s12, s12, 0x1d6000
    s_add_u32 s62, s62, 200704
    buffer_load_dwordx4 v[248:251], v135, s[24:27], s62 offen
    s_add_u32 s62, s62, 200704
    buffer_load_dwordx4 v[252:255], v135, s[24:27], s62 offen
    s_add_u32 s62, s62, 200704
    buffer_load_dwordx4 v[224:227], v135, s[24:27], s62 offen
    s_add_u32 s62, s62, 200704
    buffer_load_dwordx4 v[228:231], v135, s[24:27], s62 offen
    s_waitcnt vmcnt(6)
    v_readfirstlane_b32 s49, v15
    v_mov_b32 v6, 0
    s_barrier
    s_mul_i32 s49, s49, 0x9E3779B1
    s_add_u32 s49, s49, 0x6A09E667
    v_mov_b32 v15, s49
    s_cmp_eq_u32 s48, 0
    s_cbranch_scc0 L_hfb
    s_mov_b64 exec, 1
    buffer_store_dword v15, v6, s[32:35], s10 offen sc1
    s_mov_b64 exec, -1
L_hfb:
    s_add_u32 s62, s62, 200704
    buffer_load_dwordx4 v[232:235], v135, s[24:27], s62 offen
    s_add_u32 s62, s62, 200704
    buffer_load_dwordx4 v[236:239], v135, s[24:27], s62 offen
    s_add_u32 s62, s62, 200704
    buffer_load_dwordx4 v[240:243], v135, s[24:27], s62 offen
    s_add_u32 s62, s62, 200704
    buffer_load_dwordx4 v[244:247], v135, s[24:27], s62 offen
    s_add_u32 s62, s62, 200704
    buffer_load_dwordx4 v[248:251], v135, s[24:27], s62 offen
    s_add_u32 s62, s62, 200704
    buffer_load_dwordx4 v[252:255], v135, s[24:27], s62 offen
    s_add_u32 s62, s62, 200704
    buffer_load_dwordx4 v[224:227], v135, s[24:27], s62 offen
    s_add_u32 s62, s62, 200704
    buffer_load_dwordx4 v[228:231], v135, s[24:27], s62 offen
    s_add_u32 s62, s62, 200704
    buffer_load_dwordx4 v[232:235], v135, s[24:27], s62 offen
    s_add_u32 s62, s62, 200704
    buffer_load_dwordx4 v[236:239], v135, s[24:27], s62 offen
    s_add_u32 s62, s62, 200704
    s_min_u32 s62, s62, 7335936
    buffer_load_dwordx4 v[240:243], v135, s[24:27], s62 offen
    v_lshrrev_b32 v135, 5, v1
    v_mul_u32_u24 v135, 4096, v135
    v_and_b32 v9, 31, v1
    v_lshl_add_u32 v135, v9, 4, v135
    s_lshl_b32 s62, s3, 2
    s_add_u32 s62, s62, s48
    s_sub_u32 s62, s62, 100
    s_mul_i32 s62, s62, 8192
    s_add_u32 s62, s62, s6
    s_cmp_lt_u32 s3, 25
    s_cselect_b32 s70, 0x40000000, 0
    s_cselect_b32 s62, 0, s62
    v_add_u32 v135, s70, v135
    buffer_load_dwordx4 v[244:247], v135, s[28:31], s62 offen
    s_add_u32 s62, s62, 229376
    buffer_load_dwordx4 v[248:251], v135, s[28:31], s62 offen
    s_add_u32 s62, s62, 229376
    buffer_load_dwordx4 v[252:255], v135, s[28:31], s62 offen
    s_add_u32 s62, s62, 229376
    buffer_load_dwordx4 v[224:227], v135, s[28:31], s62 offen
    s_add_u32 s62, s62, 229376
    buffer_load_dwordx4 v[228:231], v135, s[28:31], s62 offen
    s_add_u32 s62, s62, 229376
    buffer_load_dwordx4 v[232:235], v135, s[28:31], s62 offen
    s_add_u32 s62, s62, 229376
    buffer_load_dwordx4 v[236:239], v135, s[28:31], s62 offen
    s_add_u32 s62, s62, 229376
    buffer_load_dwordx4 v[240:243], v135, s[28:31], s62 offen
    s_add_u32 s62, s62, 229376
    buffer_load_dwordx4 v[244:247], v135, s[28:31], s62 offen
    s_add_u32 s62, s62, 229376
    buffer_load_dwordx4 v[248:251], v135, s[28:31], s62 offen
    s_add_u32 s62, s62, 229376
    buffer_load_dwordx4 v[252:255], v135, s[28:31], s62 offen
    s_add_u32 s62, s62, 229376
    buffer_load_dwordx4 v[224:227], v135, s[28:31], s62 offen
    s_add_u32 s62, s62, 229376
    buffer_load_dwordx4 v[228:231], v135, s[28:31], s62 offen
    s_add_u32 s62, s62, 229376
    buffer_load_dwordx4 v[232:235], v135, s[28:31], s62 offen
    s_add_u32 s62, s62, 229376
    buffer_load_dwordx4 v[236:239], v135, s[28:31], s62 offen
    s_add_u32 s62, s62, 229376
    buffer_load_dwordx4 v[240:243], v135, s[28:31], s62 offen
    s_add_u32 s62, s62, 229376
    buffer_load_dwordx4 v[244:247], v135, s[28:31], s62 offen
    s_add_u32 s62, s62, 229376
    buffer_load_dwordx4 v[248:251], v135, s[28:31], s62 offen
    s_add_u32 s62, s62, 229376
    buffer_load_dwordx4 v[252:255], v135, s[28:31], s62 offen
    s_add_u32 s62, s62, 229376
    buffer_load_dwordx4 v[224:227], v135, s[28:31], s62 offen
    s_add_u32 s62, s62, 229376
    buffer_load_dwordx4 v[228:231], v135, s[28:31], s62 offen
    s_add_u32 s62, s62, 229376
    buffer_load_dwordx4 v[232:235], v135, s[28:31], s62 offen
    s_add_u32 s62, s62, 229376
    buffer_load_dwordx4 v[236:239], v135, s[28:31], s62 offen
    s_add_u32 s62, s62, 229376
    buffer_load_dwordx4 v[240:243], v135, s[28:31], s62 offen
    s_add_u32 s62, s62, 229376
    buffer_load_dwordx4 v[244:247], v135, s[28:31], s62 offen
    s_add_u32 s62, s62, 229376
    buffer_load_dwordx4 v[248:251], v135, s[28:31], s62 offen
    s_add_u32 s62, s62, 229376
    buffer_load_dwordx4 v[252:255], v135, s[28:31], s62 offen
    s_add_u32 s62, s62, 229376
    buffer_load_dwordx4 v[224:227], v135, s[28:31], s62 offen
    s_add_u32 s62, s62, 229376
    buffer_load_dwordx4 v[228:231], v135, s[28:31], s62 offen
    s_add_u32 s62, s62, 229376
    buffer_load_dwordx4 v[232:235], v135, s[28:31], s62 offen
    s_add_u32 s62, s62, 229376
    buffer_load_dwordx4 v[236:239], v135, s[28:31], s62 offen
    s_add_u32 s62, s62, 229376
    s_waitcnt vmcnt(31)
    buffer_load_dwordx4 v[240:243], v135, s[28:31], s62 offen
    s_waitcnt vmcnt(0)
    s_cmp_eq_u32 s55, 0
    s_cbranch_scc1 L_fin
    s_add_u32 m0, s61, 8192
    s_nop 0
    buffer_load_dwordx4 v124, s[28:31], s4 offen  lds
    buffer_load_dwordx4 v125, s[28:31], s4 offen offset:1024  lds
    buffer_load_dwordx4 v126, s[28:31], s4 offen offset:2048  lds
    buffer_load_dwordx4 v127, s[28:31], s4 offen offset:3072  lds
    s_add_u32 m0, m0, 0x1000
    s_add_u32 s4, s4, 524288
    buffer_load_dwordx4 v124, s[28:31], s4 offen  lds
    buffer_load_dwordx4 v125, s[28:31], s4 offen offset:1024  lds
    buffer_load_dwordx4 v126, s[28:31], s4 offen offset:2048  lds
    buffer_load_dwordx4 v127, s[28:31], s4 offen offset:3072  lds
    s_add_u32 m0, m0, 0x1000
    s_add_u32 s4, s4, 524288
    buffer_load_dwordx4 v124, s[28:31], s4 offen  lds
    buffer_load_dwordx4 v125, s[28:31], s4 offen offset:1024  lds
    buffer_load_dwordx4 v126, s[28:31], s4 offen offset:2048  lds
    buffer_load_dwordx4 v127, s[28:31], s4 offen offset:3072  lds
    s_add_u32 m0, m0, 0x1000
    s_add_u32 s4, s4, 524288
    buffer_load_dwordx4 v124, s[28:31], s4 offen  lds
    buffer_load_dwordx4 v125, s[28:31], s4 offen offset:1024  lds
    buffer_load_dwordx4 v126, s[28:31], s4 offen offset:2048  lds
    buffer_load_dwordx4 v127, s[28:31], s4 offen offset:3072  lds
    s_add_u32 m0, m0, 0x1000
    s_add_u32 s4, s4, 524288
    buffer_load_dwordx4 v124, s[28:31], s4 offen  lds
    buffer_load_dwordx4 v125, s[28:31], s4 offen offset:1024  lds
    buffer_load_dwordx4 v126, s[28:31], s4 offen offset:2048  lds
    buffer_load_dwordx4 v127, s[28:31], s4 offen offset:3072  lds
    s_mov_b32 m0, s61
    s_add_u32 s4, s4, 524288
    buffer_load_dwordx4 v124, s[28:31], s4 offen  lds
    buffer_load_dwordx4 v125, s[28:31], s4 offen offset:1024  lds
    buffer_load_dwordx4 v126, s[28:31], s4 offen offset:2048  lds
    buffer_load_dwordx4 v127, s[28:31], s4 offen offset:3072  lds
    s_add_u32 m0, m0, 0x1000
    s_add_u32 s4, s4, 524288
    buffer_load_dwordx4 v124, s[28:31], s4 offen  lds
    buffer_load_dwordx4 v125, s[28:31], s4 offen offset:1024  lds
    buffer_load_dwordx4 v126, s[28:31], s4 offen offset:2048  lds
    buffer_load_dwordx4 v127, s[28:31], s4 offen offset:3072  lds
    s_waitcnt vmcnt(26)
    ds_read_b64_tr_b16 a[0:1], v12 offset:8192
    ds_read_b64_tr_b16 a[2:3], v12 offset:9216
    ds_read_b64_tr_b16 a[4:5], v13 offset:8192
    ds_read_b64_tr_b16 a[6:7], v13 offset:9216
    s_waitcnt lgkmcnt(0)
    s_add_u32 m0, m0, 0x1000
    s_add_u32 s4, s4, 524288
    buffer_load_dwordx4 v124, s[28:31], s4 offen  lds
    buffer_load_dwordx4 v125, s[28:31], s4 offen offset:1024  lds
    s_waitcnt vmcnt(26)
    ds_read_b64_tr_b16 a[8:9], v12 offset:10240
    ds_read_b64_tr_b16 a[10:11], v12 offset:11264
    ds_read_b64_tr_b16 a[12:13], v13 offset:10240
    ds_read_b64_tr_b16 a[14:15], v13 offset:11264
    s_waitcnt lgkmcnt(0)
    buffer_load_dwordx4 v126, s[28:31], s4 offen offset:2048  lds
    buffer_load_dwordx4 v127, s[28:31], s4 offen offset:3072  lds
    s_waitcnt vmcnt(26)
    ds_read_b64_tr_b16 a[16:17], v12 offset:12288
    ds_read_b64_tr_b16 a[18:19], v12 offset:13312
    ds_read_b64_tr_b16 a[20:21], v13 offset:12288
    ds_read_b64_tr_b16 a[22:23], v13 offset:13312
    s_waitcnt lgkmcnt(0)
    s_add_u32 m0, m0, 0x1000
    s_add_u32 s4, s4, 524288
    buffer_load_dwordx4 v124, s[28:31], s4 offen  lds
    buffer_load_dwordx4 v125, s[28:31], s4 offen offset:1024  lds
    s_waitcnt vmcnt(26)
    ds_read_b64_tr_b16 a[24:25], v12 offset:14336
    ds_read_b64_tr_b16 a[26:27], v12 offset:15360
    ds_read_b64_tr_b16 a[28:29], v13 offset:14336
    ds_read_b64_tr_b16 a[30:31], v13 offset:15360
    s_waitcnt lgkmcnt(0)
    buffer_load_dwordx4 v126, s[28:31], s4 offen offset:2048  lds
    buffer_load_dwordx4 v127, s[28:31], s4 offen offset:3072  lds
    s_waitcnt vmcnt(26)
    ds_read_b64_tr_b16 a[32:33], v12 offset:16384
    ds_read_b64_tr_b16 a[34:35], v12 offset:17408
    ds_read_b64_tr_b16 a[36:37], v13 offset:16384
    ds_read_b64_tr_b16 a[38:39], v13 offset:17408
    s_waitcnt lgkmcnt(0)
    s_add_u32 m0, m0, 0x1000
    s_add_u32 s4, s4, 524288
    buffer_load_dwordx4 v124, s[28:31], s4 offen  lds
    buffer_load_dwordx4 v125, s[28:31], s4 offen offset:1024  lds
    s_waitcnt vmcnt(26)
    ds_read_b64_tr_b16 a[40:41], v12 offset:18432
    ds_read_b64_tr_b16 a[42:43], v12 offset:19456
    ds_read_b64_tr_b16 a[44:45], v13 offset:18432
    ds_read_b64_tr_b16 a[46:47], v13 offset:19456
    s_waitcnt lgkmcnt(0)
    buffer_load_dwordx4 v126, s[28:31], s4 offen offset:2048  lds
    buffer_load_dwordx4 v127, s[28:31], s4 offen offset:3072  lds
    s_waitcnt vmcnt(26)
    ds_read_b64_tr_b16 a[48:49], v12 offset:20480
    ds_read_b64_tr_b16 a[50:51], v12 offset:21504
    ds_read_b64_tr_b16 a[52:53], v13 offset:20480
    ds_read_b64_tr_b16 a[54:55], v13 offset:21504
    s_waitcnt lgkmcnt(0)
    s_add_u32 m0, m0, 0x1000
    s_add_u32 s4, s4, 524288
    buffer_load_dwordx4 v124, s[28:31], s4 offen  lds
    buffer_load_dwordx4 v125, s[28:31], s4 offen offset:1024  lds
    s_waitcnt vmcnt(26)
    ds_read_b64_tr_b16 a[56:57], v12 offset:22528
    ds_read_b64_tr_b16 a[58:59], v12 offset:23552
    ds_read_b64_tr_b16 a[60:61], v13 offset:22528
    ds_read_b64_tr_b16 a[62:63], v13 offset:23552
    s_waitcnt lgkmcnt(0)
    buffer_load_dwordx4 v126, s[28:31], s4 offen offset:2048  lds
    buffer_load_dwordx4 v127, s[28:31], s4 offen offset:3072  lds
    s_waitcnt vmcnt(26)
    ds_read_b64_tr_b16 a[64:65], v12 offset:24576
    ds_read_b64_tr_b16 a[66:67], v12 offset:25600
    ds_read_b64_tr_b16 a[68:69], v13 offset:24576
    ds_read_b64_tr_b16 a[70:71], v13 offset:25600
    s_waitcnt vmcnt(24)
    ds_read_b64_tr_b16 a[72:73], v12 offset:26624
    ds_read_b64_tr_b16 a[74:75], v12 offset:27648
    ds_read_b64_tr_b16 a[76:77], v13 offset:26624
    ds_read_b64_tr_b16 a[78:79], v13 offset:27648
    s_waitcnt vmcnt(22)
    ds_read_b64_tr_b16 a[80:81], v12 offset:0
    ds_read_b64_tr_b16 a[82:83], v12 offset:1024
    ds_read_b64_tr_b16 a[84:85], v13 offset:0
    ds_read_b64_tr_b16 a[86:87], v13 offset:1024
    s_waitcnt vmcnt(20)
    ds_read_b64_tr_b16 a[88:89], v12 offset:2048
    ds_read_b64_tr_b16 a[90:91], v12 offset:3072
    ds_read_b64_tr_b16 a[92:93], v13 offset:2048
    ds_read_b64_tr_b16 a[94:95], v13 offset:3072
    s_waitcnt vmcnt(18)
    ds_read_b64_tr_b16 a[96:97], v12 offset:4096
    ds_read_b64_tr_b16 a[98:99], v12 offset:5120
    ds_read_b64_tr_b16 a[100:101], v13 offset:4096
    ds_read_b64_tr_b16 a[102:103], v13 offset:5120
    s_waitcnt vmcnt(0) lgkmcnt(0)
    v_mov_b32 v9, 0
    s_mov_b32 s100, s12
    s_mov_b64 vcc, 1
    s_mov_b32 s63, 0
L_prew:
    s_mov_b64 exec, vcc
    s_sleep 6
    buffer_load_dword v7, v9, s[32:35], s100 offen sc1
    s_add_u32 s63, s63, 1
    s_waitcnt vmcnt(0)
    v_cmp_ne_u32 vcc, s49, v7
    s_cmp_ge_u32 s63, 0x40000
    s_cbranch_scc1 L_prewd
    s_cmp_eq_u64 vcc, 0
    s_cbranch_scc0 L_prew
L_prewd:
    s_mov_b64 exec, -1
    v_min_u32 v9, 27, v1
    v_lshlrev_b32 v9, 9, v9
    s_lshl_b32 s100, s52, 7
    s_add_u32 s100, s100, s48
    s_lshl_b32 s100, s100, 7
    s_add_u32 s100, s100, 0x388000
L_join:
    s_lshl_b32 s5, s52, 3
    s_add_u32 s5, s5, s48
    s_mul_i32 s5, s5, 28672
    s_add_u32 s5, s5, 0x200000
    v_lshlrev_b32 v96, 16, v8
    v_lshlrev_b32 v97, 16, v8
    v_lshlrev_b32 v98, 16, v8
    v_lshlrev_b32 v99, 16, v8
    v_lshlrev_b32 v100, 16, v8
    v_lshlrev_b32 v101, 16, v8
    v_lshlrev_b32 v102, 16, v8
    v_lshlrev_b32 v103, 16, v8
    buffer_load_dword v7, v9, s[32:35], s100 offen sc1
    s_waitcnt lgkmcnt(15)
    s_add_u32 m0, m0, 0x1000
    s_add_u32 s4, s4, 524288
    buffer_load_dwordx4 v124, s[28:31], s4 offen  lds
    buffer_load_dwordx4 v125, s[28:31], s4 offen offset:1024  lds
    s_waitcnt lgkmcnt(12)
    buffer_load_dwordx4 v126, s[28:31], s4 offen offset:2048  lds
    buffer_load_dwordx4 v127, s[28:31], s4 offen offset:3072  lds
    s_waitcnt lgkmcnt(8)
    s_mov_b32 m0, s61
    s_add_u32 s4, s4, 524288
    buffer_load_dwordx4 v124, s[28:31], s4 offen  lds
    buffer_load_dwordx4 v125, s[28:31], s4 offen offset:1024  lds
    ds_read_b64_tr_b16 a[104:105], v12 offset:6144
    ds_read_b64_tr_b16 a[106:107], v12 offset:7168
    ds_read_b64_tr_b16 a[108:109], v13 offset:6144
    ds_read_b64_tr_b16 a[110:111], v13 offset:7168
    s_waitcnt lgkmcnt(8)
    buffer_load_dwordx4 v126, s[28:31], s4 offen offset:2048  lds
    buffer_load_dwordx4 v127, s[28:31], s4 offen offset:3072  lds
    ds_read_b64_tr_b16 a[112:113], v12 offset:8192
    ds_read_b64_tr_b16 a[114:115], v12 offset:9216
    ds_read_b64_tr_b16 a[116:117], v13 offset:8192
    ds_read_b64_tr_b16 a[118:119], v13 offset:9216
    s_waitcnt lgkmcnt(8)
    s_add_u32 m0, m0, 0x1000
    s_add_u32 s4, s4, 524288
    buffer_load_dwordx4 v124, s[28:31], s4 offen  lds
    buffer_load_dwordx4 v125, s[28:31], s4 offen offset:1024  lds
    ds_read_b64_tr_b16 a[120:121], v12 offset:10240
    ds_read_b64_tr_b16 a[122:123], v12 offset:11264
    ds_read_b64_tr_b16 a[124:125], v13 offset:10240
    ds_read_b64_tr_b16 a[126:127], v13 offset:11264
    s_waitcnt lgkmcnt(8)
    buffer_load_dwordx4 v126, s[28:31], s4 offen offset:2048  lds
    buffer_load_dwordx4 v127, s[28:31], s4 offen offset:3072  lds
    s_waitcnt vmcnt(12)
    v_cmp_ne_u32 vcc, s49, v7
    s_mov_b32 s63, 0
    s_cmp_eq_u64 vcc, 0
    s_cbranch_scc1 L_polld_4
L_poll_3:
    s_mov_b64 exec, vcc
    s_sleep 6
    buffer_load_dword v7, v9, s[32:35], s100 offen sc1
    s_add_u32 s63, s63, 1
    s_waitcnt vmcnt(0)
    v_cmp_ne_u32 vcc, s49, v7
    s_cmp_ge_u32 s63, 0x40000
    s_cbranch_scc1 L_polld_4
    s_cmp_eq_u64 vcc, 0
    s_cbranch_scc0 L_poll_3
L_polld_4:
    s_mov_b64 exec, -1
    s_add_u32 s71, s5, 28672
    s_lshl_b32 s59, s67, 10
    s_add_u32 s62, s5, s59
    buffer_load_dwordx4 v[140:143], v116, s[32:35], s62 offen sc1
    ds_read_b64_tr_b16 a[128:129], v12 offset:12288
    ds_read_b64_tr_b16 a[130:131], v12 offset:13312
    ds_read_b64_tr_b16 a[132:133], v13 offset:12288
    ds_read_b64_tr_b16 a[134:135], v13 offset:13312
    buffer_load_dwordx4 v[144:147], v116, s[32:35], s62 offen offset:1024 sc1
    ds_read_b64_tr_b16 a[136:137], v12 offset:14336
    ds_read_b64_tr_b16 a[138:139], v12 offset:15360
    ds_read_b64_tr_b16 a[140:141], v13 offset:14336
    ds_read_b64_tr_b16 a[142:143], v13 offset:15360
    s_add_u32 s62, s62, 2048
    buffer_load_dwordx4 v[148:151], v116, s[32:35], s62 offen sc1
    ds_read_b64_tr_b16 a[144:145], v12 offset:16384
    ds_read_b64_tr_b16 a[146:147], v12 offset:17408
    ds_read_b64_tr_b16 a[148:149], v13 offset:16384
    ds_read_b64_tr_b16 a[150:151], v13 offset:17408
    buffer_load_dwordx4 v[152:155], v116, s[32:35], s62 offen offset:1024 sc1
    ds_read_b64_tr_b16 a[152:153], v12 offset:18432
    ds_read_b64_tr_b16 a[154:155], v12 offset:19456
    ds_read_b64_tr_b16 a[156:157], v13 offset:18432
    ds_read_b64_tr_b16 a[158:159], v13 offset:19456
    s_add_u32 s62, s62, 2048
    buffer_load_dwordx4 v[156:159], v116, s[32:35], s62 offen sc1
    ds_read_b64_tr_b16 a[160:161], v12 offset:20480
    ds_read_b64_tr_b16 a[162:163], v12 offset:21504
    ds_read_b64_tr_b16 a[164:165], v13 offset:20480
    ds_read_b64_tr_b16 a[166:167], v13 offset:21504
    buffer_load_dwordx4 v[160:163], v116, s[32:35], s62 offen offset:1024 sc1
    ds_read_b64_tr_b16 a[168:169], v12 offset:22528
    ds_read_b64_tr_b16 a[170:171], v12 offset:23552
    ds_read_b64_tr_b16 a[172:173], v13 offset:22528
    ds_read_b64_tr_b16 a[174:175], v13 offset:23552
    s_add_u32 s62, s62, 2048
    buffer_load_dwordx4 v[164:167], v116, s[32:35], s62 offen sc1
    buffer_load_dwordx4 v[168:171], v116, s[32:35], s62 offen offset:1024 sc1
    s_add_u32 s62, s62, 2048
    buffer_load_dwordx4 v[172:175], v116, s[32:35], s62 offen sc1
    buffer_load_dwordx4 v[176:179], v116, s[32:35], s62 offen offset:1024 sc1
    s_add_u32 s62, s62, 2048
    buffer_load_dwordx4 v[180:183], v116, s[32:35], s62 offen sc1
    s_waitcnt vmcnt(10)
    v_mfma_f32_32x32x16_bf16 v[32:47], v[140:143], a[4:7], 0
    buffer_load_dwordx4 v[184:187], v116, s[32:35], s62 offen offset:1024 sc1
    v_mfma_f32_32x32x16_bf16 v[16:31], v[140:143], a[0:3], 0
    ds_read_b64_tr_b16 a[176:177], v12 offset:24576
    ds_read_b64_tr_b16 a[178:179], v12 offset:25600
    ds_read_b64_tr_b16 a[180:181], v13 offset:24576
    ds_read_b64_tr_b16 a[182:183], v13 offset:25600
    ds_read_b64_tr_b16 a[184:185], v12 offset:26624
    ds_read_b64_tr_b16 a[186:187], v12 offset:27648
    ds_read_b64_tr_b16 a[188:189], v13 offset:26624
    ds_read_b64_tr_b16 a[190:191], v13 offset:27648
    s_waitcnt vmcnt(10)
    v_mfma_f32_32x32x16_bf16 v[32:47], v[144:147], a[12:15], v[32:47]
    s_add_u32 s62, s62, 2048
    buffer_load_dwordx4 v[140:143], v116, s[32:35], s62 offen sc1
    v_mfma_f32_32x32x16_bf16 v[16:31], v[144:147], a[8:11], v[16:31]
    ds_read_b64_tr_b16 a[192:193], v12 offset:0
    ds_read_b64_tr_b16 a[194:195], v12 offset:1024
    ds_read_b64_tr_b16 a[196:197], v13 offset:0
    ds_read_b64_tr_b16 a[198:199], v13 offset:1024
    ds_read_b64_tr_b16 a[200:201], v12 offset:2048
    ds_read_b64_tr_b16 a[202:203], v12 offset:3072
    ds_read_b64_tr_b16 a[204:205], v13 offset:2048
    ds_read_b64_tr_b16 a[206:207], v13 offset:3072
    s_waitcnt vmcnt(10)
    v_mfma_f32_32x32x16_bf16 v[32:47], v[148:151], a[20:23], v[32:47]
    buffer_load_dwordx4 v[144:147], v116, s[32:35], s62 offen offset:1024 sc1
    v_mfma_f32_32x32x16_bf16 v[16:31], v[148:151], a[16:19], v[16:31]
    ds_read_b64_tr_b16 a[208:209], v12 offset:4096
    ds_read_b64_tr_b16 a[210:211], v12 offset:5120
    ds_read_b64_tr_b16 a[212:213], v13 offset:4096
    ds_read_b64_tr_b16 a[214:215], v13 offset:5120
    ds_read_b64_tr_b16 a[216:217], v12 offset:6144
    ds_read_b64_tr_b16 a[218:219], v12 offset:7168
    ds_read_b64_tr_b16 a[220:221], v13 offset:6144
    ds_read_b64_tr_b16 a[222:223], v13 offset:7168
    s_waitcnt vmcnt(10)
    v_mfma_f32_32x32x16_bf16 v[32:47], v[152:155], a[28:31], v[32:47]
    s_add_u32 s62, s62, 2048
    buffer_load_dwordx4 v[148:151], v116, s[32:35], s62 offen sc1
    v_mfma_f32_32x32x16_bf16 v[16:31], v[152:155], a[24:27], v[16:31]
    s_waitcnt vmcnt(10)
    v_mfma_f32_32x32x16_bf16 v[32:47], v[156:159], a[36:39], v[32:47]
    buffer_load_dwordx4 v[152:155], v116, s[32:35], s62 offen offset:1024 sc1
    v_mfma_f32_32x32x16_bf16 v[16:31], v[156:159], a[32:35], v[16:31]
    s_waitcnt vmcnt(10)
    v_mfma_f32_32x32x16_bf16 v[32:47], v[160:163], a[44:47], v[32:47]
    s_add_u32 s62, s62, 2048
    buffer_load_dwordx4 v[156:159], v116, s[32:35], s62 offen sc1
    v_mfma_f32_32x32x16_bf16 v[16:31], v[160:163], a[40:43], v[16:31]
    s_waitcnt vmcnt(10)
    v_mfma_f32_32x32x16_bf16 v[32:47], v[164:167], a[52:55], v[32:47]
    buffer_load_dwordx4 v[160:163], v116, s[32:35], s62 offen offset:1024 sc1
    v_mfma_f32_32x32x16_bf16 v[16:31], v[164:167], a[48:51], v[16:31]
    s_waitcnt vmcnt(10)
    v_mfma_f32_32x32x16_bf16 v[32:47], v[168:171], a[60:63], v[32:47]
    s_add_u32 s62, s62, 2048
    s_add_u32 s100, s100, 114688
    buffer_load_dword v7, v9, s[32:35], s100 offen sc1
    buffer_load_dwordx4 v[164:167], v116, s[32:35], s62 offen sc1
    v_mfma_f32_32x32x16_bf16 v[16:31], v[168:171], a[56:59], v[16:31]
    s_waitcnt vmcnt(11)
    v_mfma_f32_32x32x16_bf16 v[32:47], v[172:175], a[68:71], v[32:47]
    buffer_load_dwordx4 v[168:171], v116, s[32:35], s62 offen offset:1024 sc1
    v_mfma_f32_32x32x16_bf16 v[16:31], v[172:175], a[64:67], v[16:31]
    s_waitcnt vmcnt(11)
    v_mfma_f32_32x32x16_bf16 v[32:47], v[176:179], a[76:79], v[32:47]
    s_add_u32 s62, s62, 2048
    buffer_load_dwordx4 v[172:175], v116, s[32:35], s62 offen sc1
    v_mfma_f32_32x32x16_bf16 v[16:31], v[176:179], a[72:75], v[16:31]
    s_waitcnt vmcnt(11)
    v_mfma_f32_32x32x16_bf16 v[32:47], v[180:183], a[84:87], v[32:47]
    buffer_load_dwordx4 v[176:179], v116, s[32:35], s62 offen offset:1024 sc1
    v_mfma_f32_32x32x16_bf16 v[16:31], v[180:183], a[80:83], v[16:31]
    s_waitcnt vmcnt(11)
    v_mfma_f32_32x32x16_bf16 v[32:47], v[184:187], a[92:95], v[32:47]
    s_add_u32 s62, s62, 2048
    buffer_load_dwordx4 v[180:183], v116, s[32:35], s62 offen sc1
    v_mfma_f32_32x32x16_bf16 v[16:31], v[184:187], a[88:91], v[16:31]
    s_waitcnt vmcnt(11)
    v_mfma_f32_32x32x16_bf16 v[32:47], v[140:143], a[100:103], v[32:47]
    buffer_load_dwordx4 v[184:187], v116, s[32:35], s62 offen offset:1024 sc1
    v_mfma_f32_32x32x16_bf16 v[16:31], v[140:143], a[96:99], v[16:31]
    s_waitcnt vmcnt(11)
    v_mfma_f32_32x32x16_bf16 v[32:47], v[144:147], a[108:111], v[32:47]
    s_add_u32 s62, s62, 2048
    buffer_load_dwordx4 v[140:143], v116, s[32:35], s62 offen sc1
    v_mfma_f32_32x32x16_bf16 v[16:31], v[144:147], a[104:107], v[16:31]
    s_waitcnt lgkmcnt(15)
    s_waitcnt vmcnt(11)
    v_mfma_f32_32x32x16_bf16 v[32:47], v[148:151], a[116:119], v[32:47]
    buffer_load_dwordx4 v[144:147], v116, s[32:35], s62 offen offset:1024 sc1
    v_mfma_f32_32x32x16_bf16 v[16:31], v[148:151], a[112:115], v[16:31]
    s_waitcnt vmcnt(11)
    v_mfma_f32_32x32x16_bf16 v[32:47], v[152:155], a[124:127], v[32:47]
    s_add_u32 s62, s62, 2048
    buffer_load_dwordx4 v[148:151], v116, s[32:35], s62 offen sc1
    v_mfma_f32_32x32x16_bf16 v[16:31], v[152:155], a[120:123], v[16:31]
    s_waitcnt vmcnt(11)
    v_mfma_f32_32x32x16_bf16 v[32:47], v[156:159], a[132:135], v[32:47]
    buffer_load_dwordx4 v[152:155], v116, s[32:35], s62 offen offset:1024 sc1
    v_mfma_f32_32x32x16_bf16 v[16:31], v[156:159], a[128:131], v[16:31]
    s_waitcnt vmcnt(11)
    v_mfma_f32_32x32x16_bf16 v[32:47], v[160:163], a[140:143], v[32:47]
    s_waitcnt vmcnt(10)
    v_cmp_ne_u32 vcc, s49, v7
    s_mov_b32 s63, 0
    s_cmp_eq_u64 vcc, 0
    s_cbranch_scc1 L_polld_6
L_poll_5:
    s_mov_b64 exec, vcc
    s_sleep 6
    buffer_load_dword v7, v9, s[32:35], s100 offen sc1
    s_add_u32 s63, s63, 1
    s_waitcnt vmcnt(0)
    v_cmp_ne_u32 vcc, s49, v7
    s_cmp_ge_u32 s63, 0x40000
    s_cbranch_scc1 L_polld_6
    s_cmp_eq_u64 vcc, 0
    s_cbranch_scc0 L_poll_5
L_polld_6:
    s_mov_b64 exec, -1
    s_add_u32 s5, s5, 114688
    s_add_u32 s71, s5, 28672
    s_lshl_b32 s59, s67, 10
    s_add_u32 s62, s5, s59
    buffer_load_dwordx4 v[156:159], v116, s[32:35], s62 offen sc1
    v_mfma_f32_32x32x16_bf16 v[16:31], v[160:163], a[136:139], v[16:31]
    s_waitcnt vmcnt(10)
    v_mfma_f32_32x32x16_bf16 v[32:47], v[164:167], a[148:151], v[32:47]
    buffer_load_dwordx4 v[160:163], v116, s[32:35], s62 offen offset:1024 sc1
    v_mfma_f32_32x32x16_bf16 v[16:31], v[164:167], a[144:147], v[16:31]
    s_waitcnt vmcnt(10)
    v_mfma_f32_32x32x16_bf16 v[32:47], v[168:171], a[156:159], v[32:47]
    s_add_u32 s62, s62, 2048
    buffer_load_dwordx4 v[164:167], v116, s[32:35], s62 offen sc1
    v_mfma_f32_32x32x16_bf16 v[16:31], v[168:171], a[152:155], v[16:31]
    s_waitcnt vmcnt(10)
    v_mfma_f32_32x32x16_bf16 v[32:47], v[172:175], a[164:167], v[32:47]
    buffer_load_dwordx4 v[168:171], v116, s[32:35], s62 offen offset:1024 sc1
    v_mfma_f32_32x32x16_bf16 v[16:31], v[172:175], a[160:163], v[16:31]
    s_waitcnt vmcnt(10)
    v_mfma_f32_32x32x16_bf16 v[32:47], v[176:179], a[172:175], v[32:47]
    s_add_u32 s62, s62, 2048
    buffer_load_dwordx4 v[172:175], v116, s[32:35], s62 offen sc1
    v_mfma_f32_32x32x16_bf16 v[16:31], v[176:179], a[168:171], v[16:31]
    s_waitcnt vmcnt(10)
    v_mfma_f32_32x32x16_bf16 v[32:47], v[180:183], a[180:183], v[32:47]
    buffer_load_dwordx4 v[176:179], v116, s[32:35], s62 offen offset:1024 sc1
    v_mfma_f32_32x32x16_bf16 v[16:31], v[180:183], a[176:179], v[16:31]
    s_waitcnt vmcnt(10)
    v_mfma_f32_32x32x16_bf16 v[32:47], v[184:187], a[188:191], v[32:47]
    s_add_u32 s62, s62, 2048
    buffer_load_dwordx4 v[180:183], v116, s[32:35], s62 offen sc1
    v_mfma_f32_32x32x16_bf16 v[16:31], v[184:187], a[184:187], v[16:31]
    s_waitcnt lgkmcnt(12)
    s_waitcnt vmcnt(10)
    v_mfma_f32_32x32x16_bf16 v[32:47], v[140:143], a[196:199], v[32:47]
    buffer_load_dwordx4 v[184:187], v116, s[32:35], s62 offen offset:1024 sc1
    v_mfma_f32_32x32x16_bf16 v[16:31], v[140:143], a[192:195], v[16:31]
    s_waitcnt lgkmcnt(8)
    s_waitcnt vmcnt(10)
    v_mfma_f32_32x32x16_bf16 v[32:47], v[144:147], a[204:207], v[32:47]
    s_add_u32 s62, s62, 2048
    buffer_load_dwordx4 v[140:143], v116, s[32:35], s62 offen sc1
    v_mfma_f32_32x32x16_bf16 v[16:31], v[144:147], a[200:203], v[16:31]
    s_waitcnt lgkmcnt(4)
    s_waitcnt vmcnt(10)
    v_mfma_f32_32x32x16_bf16 v[32:47], v[148:151], a[212:215], v[32:47]
    buffer_load_dwordx4 v[144:147], v116, s[32:35], s62 offen offset:1024 sc1
    v_mfma_f32_32x32x16_bf16 v[16:31], v[148:151], a[208:211], v[16:31]
    s_waitcnt lgkmcnt(0)
    s_waitcnt vmcnt(10)
    v_mfma_f32_32x32x16_bf16 v[32:47], v[152:155], a[220:223], v[32:47]
    s_add_u32 s62, s62, 2048
    buffer_load_dwordx4 v[148:151], v116, s[32:35], s62 offen sc1
    v_mfma_f32_32x32x16_bf16 v[16:31], v[152:155], a[216:219], v[16:31]
    s_waitcnt vmcnt(10)
    v_mfma_f32_32x32x16_bf16 v[64:79], v[156:159], a[4:7], 0
    buffer_load_dwordx4 v[152:155], v116, s[32:35], s62 offen offset:1024 sc1
    v_mfma_f32_32x32x16_bf16 v[48:63], v[156:159], a[0:3], 0
    s_waitcnt vmcnt(10)
    v_mfma_f32_32x32x16_bf16 v[64:79], v[160:163], a[12:15], v[64:79]
    s_add_u32 s62, s62, 2048
    buffer_load_dwordx4 v[156:159], v116, s[32:35], s62 offen sc1
    v_mfma_f32_32x32x16_bf16 v[48:63], v[160:163], a[8:11], v[48:63]
    s_waitcnt vmcnt(10)
    v_mfma_f32_32x32x16_bf16 v[64:79], v[164:167], a[20:23], v[64:79]
    buffer_load_dwordx4 v[160:163], v116, s[32:35], s62 offen offset:1024 sc1
    v_mfma_f32_32x32x16_bf16 v[48:63], v[164:167], a[16:19], v[48:63]
    s_waitcnt vmcnt(10)
    v_mfma_f32_32x32x16_bf16 v[64:79], v[168:171], a[28:31], v[64:79]
    s_add_u32 s62, s62, 2048
    buffer_load_dwordx4 v[164:167], v116, s[32:35], s62 offen sc1
    ds_write_b128 v129, v[32:35] offset:2048
    v_mfma_f32_32x32x16_bf16 v[48:63], v[168:171], a[24:27], v[48:63]
    ds_write_b128 v129, v[36:39] offset:3072
    ds_write_b128 v130, v[40:43] offset:4096
    s_waitcnt vmcnt(10)
    v_mfma_f32_32x32x16_bf16 v[64:79], v[172:175], a[36:39], v[64:79]
    buffer_load_dwordx4 v[168:171], v116, s[32:35], s62 offen offset:1024 sc1
    ds_write_b128 v130, v[44:47] offset:5120
    v_mfma_f32_32x32x16_bf16 v[48:63], v[172:175], a[32:35], v[48:63]
    ds_write_b128 v128, v[24:27] offset:0
    ds_write_b128 v128, v[28:31] offset:1024
    s_waitcnt vmcnt(10)
    v_mfma_f32_32x32x16_bf16 v[64:79], v[176:179], a[44:47], v[64:79]
    s_add_u32 s62, s62, 2048
    buffer_load_dwordx4 v[172:175], v116, s[32:35], s62 offen sc1
    v_mfma_f32_32x32x16_bf16 v[48:63], v[176:179], a[40:43], v[48:63]
    s_waitcnt vmcnt(10)
    v_mfma_f32_32x32x16_bf16 v[64:79], v[180:183], a[52:55], v[64:79]
    buffer_load_dwordx4 v[176:179], v116, s[32:35], s62 offen offset:1024 sc1
    v_mfma_f32_32x32x16_bf16 v[48:63], v[180:183], a[48:51], v[48:63]
    s_waitcnt vmcnt(10)
    v_mfma_f32_32x32x16_bf16 v[64:79], v[184:187], a[60:63], v[64:79]
    s_add_u32 s62, s62, 2048
    buffer_load_dwordx4 v[180:183], v116, s[32:35], s62 offen sc1
    s_waitcnt lgkmcnt(0)
    s_barrier
    ds_read_b128 v[24:27], v131 offset:0
    v_mfma_f32_32x32x16_bf16 v[48:63], v[184:187], a[56:59], v[48:63]
    ds_read_b128 v[32:35], v131 offset:2048
    ds_read_b128 v[40:43], v131 offset:4096
    ds_read_b128 v[28:31], v131 offset:1024
    s_waitcnt vmcnt(10)
    v_mfma_f32_32x32x16_bf16 v[64:79], v[140:143], a[68:71], v[64:79]
    buffer_load_dwordx4 v[184:187], v116, s[32:35], s62 offen offset:1024 sc1
    ds_read_b128 v[36:39], v131 offset:3072
    ds_read_b128 v[44:47], v131 offset:5120
    v_mfma_f32_32x32x16_bf16 v[48:63], v[140:143], a[64:67], v[48:63]
    s_waitcnt vmcnt(10)
    v_mfma_f32_32x32x16_bf16 v[64:79], v[144:147], a[76:79], v[64:79]
    s_add_u32 s62, s62, 2048
    buffer_load_dwordx4 v[140:143], v116, s[32:35], s62 offen sc1
    v_mfma_f32_32x32x16_bf16 v[48:63], v[144:147], a[72:75], v[48:63]
    s_waitcnt vmcnt(10)
    v_mfma_f32_32x32x16_bf16 v[64:79], v[148:151], a[84:87], v[64:79]
    buffer_load_dwordx4 v[144:147], v116, s[32:35], s62 offen offset:1024 sc1
    s_waitcnt lgkmcnt(3)
    v_pk_add_f32 v[32:33], v[32:33], v[40:41]
    v_pk_add_f32 v[16:17], v[16:17], v[24:25]
    v_mfma_f32_32x32x16_bf16 v[48:63], v[148:151], a[80:83], v[48:63]
    v_pk_add_f32 v[34:35], v[34:35], v[42:43]
    v_pk_add_f32 v[18:19], v[18:19], v[26:27]
    v_pk_add_f32 v[16:17], v[16:17], v[32:33]
    v_pk_add_f32 v[18:19], v[18:19], v[34:35]
    s_waitcnt lgkmcnt(0)
    v_pk_add_f32 v[36:37], v[36:37], v[44:45]
    s_waitcnt vmcnt(10)
    v_mfma_f32_32x32x16_bf16 v[64:79], v[152:155], a[92:95], v[64:79]
    s_add_u32 s62, s62, 2048
    buffer_load_dwordx4 v[148:151], v116, s[32:35], s62 offen sc1
    v_pk_add_f32 v[20:21], v[20:21], v[28:29]
    v_pk_add_f32 v[38:39], v[38:39], v[46:47]
    v_pk_add_f32 v[22:23], v[22:23], v[30:31]
    v_mfma_f32_32x32x16_bf16 v[48:63], v[152:155], a[88:91], v[48:63]
    v_pk_add_f32 v[20:21], v[20:21], v[36:37]
    v_pk_add_f32 v[22:23], v[22:23], v[38:39]
    v_cvt_pk_bf16_f32 v88, v16, v17
    v_cvt_pk_bf16_f32 v89, v18, v19
    v_cvt_pk_bf16_f32 v90, v20, v21
    v_cvt_pk_bf16_f32 v91, v22, v23
    s_waitcnt vmcnt(10)
    v_mfma_f32_32x32x16_bf16 v[64:79], v[156:159], a[100:103], v[64:79]
    buffer_load_dwordx4 v[152:155], v116, s[32:35], s62 offen offset:1024 sc1
    v_lshlrev_b32 v16, 16, v88
    v_and_b32 v17, 0xffff0000, v88
    v_lshlrev_b32 v18, 16, v89
    v_mfma_f32_32x32x16_bf16 v[48:63], v[156:159], a[96:99], v[48:63]
    v_and_b32 v19, 0xffff0000, v89
    v_lshlrev_b32 v20, 16, v90
    v_and_b32 v21, 0xffff0000, v90
    v_lshlrev_b32 v22, 16, v91
    v_and_b32 v23, 0xffff0000, v91
    v_pk_add_f32 v[16:17], v[16:17], v[96:97]
    s_waitcnt vmcnt(10)
    v_mfma_f32_32x32x16_bf16 v[64:79], v[160:163], a[108:111], v[64:79]
    s_add_u32 s62, s62, 2048
    buffer_load_dwordx4 v[156:159], v116, s[32:35], s62 offen sc1
    v_pk_add_f32 v[18:19], v[18:19], v[98:99]
    v_pk_add_f32 v[20:21], v[20:21], v[100:101]
    v_pk_add_f32 v[22:23], v[22:23], v[102:103]
    v_mfma_f32_32x32x16_bf16 v[48:63], v[160:163], a[104:107], v[48:63]
    v_cvt_pk_bf16_f32 v88, v16, v17
    v_cvt_pk_bf16_f32 v89, v18, v19
    v_cvt_pk_bf16_f32 v90, v20, v21
    v_cvt_pk_bf16_f32 v91, v22, v23
    s_nop 1
    v_permlane32_swap_b32 v88, v90
    v_permlane32_swap_b32 v89, v91
    buffer_store_dwordx4 v[88:91], v14, s[36:39], s14 offen offset:0
    s_waitcnt vmcnt(11)
    v_mfma_f32_32x32x16_bf16 v[64:79], v[164:167], a[116:119], v[64:79]
    buffer_load_dwordx4 v[160:163], v116, s[32:35], s62 offen offset:1024 sc1
    v_mfma_f32_32x32x16_bf16 v[48:63], v[164:167], a[112:115], v[48:63]
    s_waitcnt vmcnt(11)
    v_mfma_f32_32x32x16_bf16 v[64:79], v[168:171], a[124:127], v[64:79]
    s_add_u32 s62, s62, 2048
    buffer_load_dwordx4 v[164:167], v116, s[32:35], s62 offen sc1
    v_mfma_f32_32x32x16_bf16 v[48:63], v[168:171], a[120:123], v[48:63]
    s_waitcnt vmcnt(11)
    v_mfma_f32_32x32x16_bf16 v[64:79], v[172:175], a[132:135], v[64:79]
    buffer_load_dwordx4 v[168:171], v116, s[32:35], s62 offen offset:1024 sc1
    v_mfma_f32_32x32x16_bf16 v[48:63], v[172:175], a[128:131], v[48:63]
    s_waitcnt vmcnt(11)
    v_mfma_f32_32x32x16_bf16 v[64:79], v[176:179], a[140:143], v[64:79]
    v_mfma_f32_32x32x16_bf16 v[48:63], v[176:179], a[136:139], v[48:63]
    s_waitcnt vmcnt(10)
    v_mfma_f32_32x32x16_bf16 v[64:79], v[180:183], a[148:151], v[64:79]
    v_mfma_f32_32x32x16_bf16 v[48:63], v[180:183], a[144:147], v[48:63]
    s_waitcnt vmcnt(9)
    v_mfma_f32_32x32x16_bf16 v[64:79], v[184:187], a[156:159], v[64:79]
    v_mfma_f32_32x32x16_bf16 v[48:63], v[184:187], a[152:155], v[48:63]
    s_waitcnt vmcnt(8)
    v_mfma_f32_32x32x16_bf16 v[64:79], v[140:143], a[164:167], v[64:79]
    v_mfma_f32_32x32x16_bf16 v[48:63], v[140:143], a[160:163], v[48:63]
    s_waitcnt vmcnt(7)
    v_mfma_f32_32x32x16_bf16 v[64:79], v[144:147], a[172:175], v[64:79]
    v_mfma_f32_32x32x16_bf16 v[48:63], v[144:147], a[168:171], v[48:63]
    s_waitcnt vmcnt(6)
    v_mfma_f32_32x32x16_bf16 v[64:79], v[148:151], a[180:183], v[64:79]
    v_mfma_f32_32x32x16_bf16 v[48:63], v[148:151], a[176:179], v[48:63]
    s_waitcnt vmcnt(5)
    v_mfma_f32_32x32x16_bf16 v[64:79], v[152:155], a[188:191], v[64:79]
    v_mfma_f32_32x32x16_bf16 v[48:63], v[152:155], a[184:187], v[48:63]
    s_waitcnt vmcnt(4)
    v_mfma_f32_32x32x16_bf16 v[64:79], v[156:159], a[196:199], v[64:79]
    v_mfma_f32_32x32x16_bf16 v[48:63], v[156:159], a[192:195], v[48:63]
    s_waitcnt vmcnt(2)
    v_mfma_f32_32x32x16_bf16 v[64:79], v[160:163], a[204:207], v[64:79]
    v_mfma_f32_32x32x16_bf16 v[48:63], v[160:163], a[200:203], v[48:63]
    s_waitcnt vmcnt(1)
    v_mfma_f32_32x32x16_bf16 v[64:79], v[164:167], a[212:215], v[64:79]
    v_mfma_f32_32x32x16_bf16 v[48:63], v[164:167], a[208:211], v[48:63]
    s_waitcnt vmcnt(0)
    v_mfma_f32_32x32x16_bf16 v[64:79], v[168:171], a[220:223], v[64:79]
    v_mfma_f32_32x32x16_bf16 v[48:63], v[168:171], a[216:219], v[48:63]
    s_nop 10
    ds_write_b128 v129, v[64:67] offset:26624
    ds_write_b128 v129, v[68:71] offset:27648
    ds_write_b128 v130, v[72:75] offset:28672
    ds_write_b128 v130, v[76:79] offset:29696
    ds_write_b128 v128, v[56:59] offset:24576
    ds_write_b128 v128, v[60:63] offset:25600
    s_waitcnt lgkmcnt(0)
    s_barrier
    ds_read_b128 v[56:59], v131 offset:24576
    ds_read_b128 v[64:67], v131 offset:26624
    ds_read_b128 v[72:75], v131 offset:28672
    ds_read_b128 v[60:63], v131 offset:25600
    ds_read_b128 v[68:71], v131 offset:27648
    ds_read_b128 v[76:79], v131 offset:29696
    s_waitcnt lgkmcnt(3)
    v_pk_add_f32 v[64:65], v[64:65], v[72:73]
    v_pk_add_f32 v[48:49], v[48:49], v[56:57]
    v_pk_add_f32 v[66:67], v[66:67], v[74:75]
    v_pk_add_f32 v[50:51], v[50:51], v[58:59]
    v_pk_add_f32 v[48:49], v[48:49], v[64:65]
    v_pk_add_f32 v[50:51], v[50:51], v[66:67]
    s_waitcnt lgkmcnt(0)
    v_pk_add_f32 v[68:69], v[68:69], v[76:77]
    v_pk_add_f32 v[52:53], v[52:53], v[60:61]
    v_pk_add_f32 v[70:71], v[70:71], v[78:79]
    v_pk_add_f32 v[54:55], v[54:55], v[62:63]
    v_pk_add_f32 v[52:53], v[52:53], v[68:69]
    v_pk_add_f32 v[54:55], v[54:55], v[70:71]
    v_cvt_pk_bf16_f32 v92, v48, v49
    v_cvt_pk_bf16_f32 v93, v50, v51
    v_cvt_pk_bf16_f32 v94, v52, v53
    v_cvt_pk_bf16_f32 v95, v54, v55
    v_lshlrev_b32 v48, 16, v92
    v_and_b32 v49, 0xffff0000, v92
    v_lshlrev_b32 v50, 16, v93
    v_and_b32 v51, 0xffff0000, v93
    v_lshlrev_b32 v52, 16, v94
    v_and_b32 v53, 0xffff0000, v94
    v_lshlrev_b32 v54, 16, v95
    v_and_b32 v55, 0xffff0000, v95
    v_pk_add_f32 v[48:49], v[48:49], v[96:97]
    v_pk_add_f32 v[50:51], v[50:51], v[98:99]
    v_pk_add_f32 v[52:53], v[52:53], v[100:101]
    v_pk_add_f32 v[54:55], v[54:55], v[102:103]
    v_cvt_pk_bf16_f32 v92, v48, v49
    v_cvt_pk_bf16_f32 v93, v50, v51
    v_cvt_pk_bf16_f32 v94, v52, v53
    v_cvt_pk_bf16_f32 v95, v54, v55
    s_nop 1
    v_permlane32_swap_b32 v92, v94
    v_permlane32_swap_b32 v93, v95
    buffer_store_dwordx4 v[92:95], v14, s[36:39], s14 offen offset:64
L_fin:
L_end:
    s_endpgm
.section .rodata,"a"
.p2align 6
.amdhsa_kernel standalone__mixer_token_mlp__prompt_kernel
  .amdhsa_next_free_vgpr 512
  .amdhsa_next_free_sgpr 102
  .amdhsa_accum_offset 256
  .amdhsa_group_segment_fixed_size 0
  .amdhsa_kernarg_size 64
  .amdhsa_user_sgpr_count 2
  .amdhsa_user_sgpr_kernarg_segment_ptr 1
  .amdhsa_system_sgpr_workgroup_id_x 1
  .amdhsa_float_denorm_mode_32 3
.end_amdhsa_kernel
```
